```python
import torch

def _softmax(x, axis=-1):
    return torch.softmax(x, dim=axis)
def _gelu(x):
    return torch.nn.functional.gelu(x, approximate="tanh")
def _silu(x):
    return torch.nn.functional.silu(x)
def _sigmoid(x):
    return torch.sigmoid(x)
def _layernorm(x, axis=-1, eps=1e-5):
    m = x.mean(dim=axis, keepdim=True)
    v = x.var(dim=axis, keepdim=True, unbiased=False)
    return (x - m) / torch.sqrt(v + eps)
def _scatter_add(tgt, idx, src, axis=0):
    return tgt.clone().index_add_(axis, idx, src)
def _segment_sum(src, seg, n):
    out = torch.zeros((n,) + src.shape[1:], dtype=src.dtype)
    return out.index_add_(0, seg, src)
def _pad(x, pw):
    flat = tuple(v for pair in reversed(pw) for v in pair)
    return torch.nn.functional.pad(x, flat)

kernel_name = 'gated_mix__sliding_local_dilated__mixer_token_mlp__prompt'

def setup_inputs():

    _w = (lambda a: (lambda t: t.to(torch.bfloat16) if t.is_floating_point() else t)(torch.as_tensor(a)))
    def _A_setup():
        B, S, D = 1, 2048, 1024
        return {
            "x": _w((lambda *s: torch.randn(*s, dtype=torch.bfloat16) * 0.05)(B, S, D)),
            "wqkv": _w((lambda *s: torch.randn(*s, dtype=torch.bfloat16) * 0.8)(D, 3 * D)),
            "wo": _w((lambda *s: torch.randn(*s, dtype=torch.bfloat16) * 0.05)(D, D)),
        }
    _A_in = _A_setup()

    def _B_setup():
        B, S, D, F = 1, 2048, 1024, 3584
        return {
            "x": _w((lambda *s: torch.randn(*s, dtype=torch.bfloat16) * 0.05)(B, S, D)),
            "w1": _w((lambda *s: torch.randn(*s, dtype=torch.bfloat16) * 3.2)(S, F) * (S ** -0.5)),
            "b1": _w((lambda *s: torch.randn(*s, dtype=torch.bfloat16) * 3.2)(F) * 0.02),
            "w2": _w((lambda *s: torch.randn(*s, dtype=torch.bfloat16) * 0.2)(F, S) * (F ** -0.5)),
            "b2": _w((lambda *s: torch.randn(*s, dtype=torch.bfloat16) * 0.2)(S) * 0.02),
        }
    _B_in = _B_setup()

    return {
        "A_x": _A_in["x"],
        "A_wqkv": _A_in["wqkv"],
        "A_wo": _A_in["wo"],
        "B_x": _B_in["x"],
        "B_w1": _B_in["w1"],
        "B_b1": _B_in["b1"],
        "B_w2": _B_in["w2"],
        "B_b2": _B_in["b2"],
        "gate_w": _w((lambda *s: torch.randn(*s, dtype=torch.bfloat16) * 0.05)(1024) * 16.0),
    }

def reference(A_x, A_wqkv, A_wo, B_x, B_w1, B_b1, B_w2, B_b2, gate_w):
    def _A_ref(x, wqkv, wo):
        B, S, D = x.shape
        H = 32; Dh = D // H
        W, dil = 8, 2
        qkv = (lambda x, *d: x.permute(*d))((x @ wqkv).reshape(B, S, 3, H, Dh), 2, 0, 3, 1, 4)
        q, k, v = qkv[0], qkv[1], qkv[2]
        scale = Dh ** -0.5
        pos = torch.arange(S)
        off = torch.arange(W) * dil
        idx = pos[:, None] - off[None, :]
        mask = idx >= 0
        idx_c = torch.where(mask, idx, 0).reshape(-1)
        kg = k[:, :, idx_c, :].reshape(B, H, S, W, Dh)
        vg = v[:, :, idx_c, :].reshape(B, H, S, W, Dh)
        logits = torch.einsum("bhsd,bhswd->bhsw", q, kg) * scale
        logits = torch.where(mask[None, None, :, :], logits, -1e9)
        attn = _softmax(logits, axis=-1)
        o = torch.einsum("bhsw,bhswd->bhsd", attn, vg)
        return (lambda x, *d: x.permute(*d))(o, 0, 2, 1, 3).reshape(B, S, D) @ wo

    def _B_ref(x, w1, b1, w2, b2):
        B, S, D = x.shape
        h = _layernorm(x, axis=-1)
        u = torch.einsum("bsd,sf->bdf", h, w1) + b1
        u = _gelu(u)
        y = torch.einsum("bdf,fs->bds", u, w2) + b2
        return (lambda x, *d: x.permute(*d))(y, 0, 2, 1)

    x = A_x
    g = _sigmoid((x * gate_w).sum(-1, keepdims=True))
    a = _A_ref(x, A_wqkv, A_wo)
    b = _B_ref(x, B_w1, B_b1, B_w2, B_b2)
    return g * a + (1 - g) * b
```

```asm
; @launch grid=(256,1,1) block=(512,1,1) lds=163840
.amdgcn_target "amdgcn-amd-amdhsa--gfx950"
.text
.globl gated_mix__sliding_local_dilated__mixer_token_mlp__prompt_kernel
.p2align 8
.type gated_mix__sliding_local_dilated__mixer_token_mlp__prompt_kernel,@function
gated_mix__sliding_local_dilated__mixer_token_mlp__prompt_kernel:
    s_cmp_ge_u32 s2, 256
    s_cbranch_scc1 L_end
    s_load_dwordx16 s[4:19], s[0:1], 0
    s_load_dwordx8 s[20:27], s[0:1], 64
    v_lshrrev_b32 v1, 6, v0
    v_and_b32 v0, 63, v0
    v_readfirstlane_b32 s3, v1
L_pc:
    s_and_b32 s28, s2, 7
    s_lshr_b32 s29, s2, 3
    s_and_b32 s30, s28, 1
    s_lshl_b32 s30, s30, 3
    s_and_b32 s32, s29, 7
    s_add_u32 s30, s30, s32
    s_lshr_b32 s31, s28, 1
    s_lshl_b32 s31, s31, 2
    s_lshr_b32 s33, s29, 3
    s_add_u32 s31, s31, s33
    s_cmp_lt_u32 s3, 4
    s_cbranch_scc1 L_consumer
L_loader:
    s_sub_u32 s34, s3, 4
    v_lshrrev_b32 v112, 3, v0
    v_and_b32 v113, 7, v0
    s_mul_i32 s36, s34, 36
    v_add_u32 v114, s36, v112
    s_lshl_b32 s37, s30, 7
    s_sub_u32 s37, s37, 16
    v_add_u32 v115, 0, v114
    v_bfe_u32 v116, v115, 1, 3
    v_xor_b32 v116, v116, v113
    v_add_u32 v115, s37, v115
    v_max_i32 v115, 0, v115
    v_lshlrev_b32 v115, 11, v115
    v_lshl_add_u32 v2, v116, 4, v115
    v_add_u32 v115, 8, v114
    v_bfe_u32 v116, v115, 1, 3
    v_xor_b32 v116, v116, v113
    v_add_u32 v115, s37, v115
    v_max_i32 v115, 0, v115
    v_lshlrev_b32 v115, 11, v115
    v_lshl_add_u32 v3, v116, 4, v115
    v_add_u32 v115, 16, v114
    v_bfe_u32 v116, v115, 1, 3
    v_xor_b32 v116, v116, v113
    v_add_u32 v115, s37, v115
    v_max_i32 v115, 0, v115
    v_lshlrev_b32 v115, 11, v115
    v_lshl_add_u32 v4, v116, 4, v115
    v_add_u32 v115, 24, v114
    v_bfe_u32 v116, v115, 1, 3
    v_xor_b32 v116, v116, v113
    v_add_u32 v115, s37, v115
    v_max_i32 v115, 0, v115
    v_lshlrev_b32 v115, 11, v115
    v_lshl_add_u32 v5, v116, 4, v115
    v_add_u32 v115, 32, v114
    v_bfe_u32 v116, v115, 1, 3
    v_xor_b32 v116, v116, v113
    v_add_u32 v115, s37, v115
    v_max_i32 v115, 0, v115
    v_lshlrev_b32 v115, 11, v115
    v_lshl_add_u32 v6, v116, 4, v115
    s_mov_b32 s36, 6144
    v_mul_lo_u32 v115, v112, s36
    v_bfe_u32 v116, v0, 4, 1
    v_lshlrev_b32 v116, 1, v116
    v_xor_b32 v116, v116, v113
    v_lshl_add_u32 v117, v116, 4, v115
    v_xor_b32 v118, 64, v117
    s_mul_i32 s37, s34, 6
    s_add_u32 s36, s37, 0
    s_and_b32 s0, s36, 7
    s_mul_i32 s0, s0, 49152
    s_lshr_b32 s1, s36, 3
    s_lshl_b32 s1, s1, 11
    s_add_u32 s0, s0, s1
    v_add_u32 v7, s0, v117
    s_add_u32 s36, s37, 1
    s_and_b32 s0, s36, 7
    s_mul_i32 s0, s0, 49152
    s_lshr_b32 s1, s36, 3
    s_lshl_b32 s1, s1, 11
    s_add_u32 s0, s0, s1
    v_add_u32 v8, s0, v118
    s_add_u32 s36, s37, 2
    s_and_b32 s0, s36, 7
    s_mul_i32 s0, s0, 49152
    s_lshr_b32 s1, s36, 3
    s_lshl_b32 s1, s1, 11
    s_add_u32 s0, s0, s1
    v_add_u32 v9, s0, v117
    s_add_u32 s36, s37, 3
    s_and_b32 s0, s36, 7
    s_mul_i32 s0, s0, 49152
    s_lshr_b32 s1, s36, 3
    s_lshl_b32 s1, s1, 11
    s_add_u32 s0, s0, s1
    v_add_u32 v10, s0, v118
    s_add_u32 s36, s37, 4
    s_and_b32 s0, s36, 7
    s_mul_i32 s0, s0, 49152
    s_lshr_b32 s1, s36, 3
    s_lshl_b32 s1, s1, 11
    s_add_u32 s0, s0, s1
    v_add_u32 v11, s0, v117
    s_add_u32 s36, s37, 5
    s_and_b32 s0, s36, 7
    s_mul_i32 s0, s0, 49152
    s_lshr_b32 s1, s36, 3
    s_lshl_b32 s1, s1, 11
    s_add_u32 s0, s0, s1
    v_add_u32 v12, s0, v118
    s_mul_i32 s90, s34, 4608
    s_mul_i32 s91, s34, 6144
    s_add_u32 s91, s91, 18432
    s_lshl_b32 s92, s31, 7
    s_mul_i32 s93, s32, 1
    s_mul_i32 s36, s33, 2
    s_add_u32 s93, s93, s36
    s_mov_b32 s94, 0
    s_mov_b32 s95, 0
    s_waitcnt lgkmcnt(0)
    s_mov_b32 s44, s4
    s_mov_b32 s45, s5
    s_mov_b32 s46, 0x400000
    s_mov_b32 s47, 0x20000
    s_mov_b32 s48, s6
    s_mov_b32 s49, s7
    s_mov_b32 s50, 0x600000
    s_mov_b32 s51, 0x20000
L_l1pro:
    s_add_u32 s96, s95, s93
    s_and_b32 s96, s96, 3
    s_andn2_b32 s36, s95, 3
    s_or_b32 s96, s96, s36
    s_lshl_b32 s0, s96, 7
    s_mul_i32 s1, s96, 393216
    s_add_u32 s1, s1, s92
    s_add_u32 s97, s94, s90
    s_add_u32 m0, s97, 0
    s_nop 0
    buffer_load_dwordx4 v2, s[44:47], s0 offen lds
    s_add_u32 m0, s97, 1024
    s_nop 0
    buffer_load_dwordx4 v3, s[44:47], s0 offen lds
    s_add_u32 m0, s97, 2048
    s_nop 0
    buffer_load_dwordx4 v4, s[44:47], s0 offen lds
    s_add_u32 m0, s97, 3072
    s_nop 0
    buffer_load_dwordx4 v5, s[44:47], s0 offen lds
    s_add_u32 m0, s97, 4096
    s_mov_b32 exec_hi, 0
    buffer_load_dwordx4 v6, s[44:47], s0 offen lds
    s_mov_b64 exec, -1
    s_add_u32 s97, s94, s91
    s_add_u32 m0, s97, 0
    s_nop 0
    buffer_load_dwordx4 v7, s[48:51], s1 offen lds
    s_add_u32 m0, s97, 1024
    s_nop 0
    buffer_load_dwordx4 v8, s[48:51], s1 offen lds
    s_add_u32 m0, s97, 2048
    s_nop 0
    buffer_load_dwordx4 v9, s[48:51], s1 offen lds
    s_add_u32 m0, s97, 3072
    s_nop 0
    buffer_load_dwordx4 v10, s[48:51], s1 offen lds
    s_add_u32 m0, s97, 4096
    s_nop 0
    buffer_load_dwordx4 v11, s[48:51], s1 offen lds
    s_add_u32 m0, s97, 5120
    s_nop 0
    buffer_load_dwordx4 v12, s[48:51], s1 offen lds
    s_add_u32 s94, s94, 43008
    s_cmp_eq_u32 s94, 129024
    s_cselect_b32 s94, 0, s94
    s_add_u32 s95, s95, 1
    s_cmp_lt_u32 s95, 2
    s_cbranch_scc1 L_l1pro
    s_mov_b32 s40, s26
    s_mov_b32 s41, s27
    s_mov_b32 s42, 0x1a18000
    s_mov_b32 s43, 0x20000
    s_mov_b32 s52, s20
    s_mov_b32 s53, s21
    s_mov_b32 s54, 0x800
    s_mov_b32 s55, 0x20000
    s_mov_b32 s56, s12
    s_mov_b32 s57, s13
    s_mov_b32 s58, 0xe00000
    s_mov_b32 s59, 0x20000
    s_mov_b32 s60, s14
    s_mov_b32 s61, s15
    s_mov_b32 s62, 0x1c00
    s_mov_b32 s63, 0x20000
    s_mov_b32 s64, s8
    s_mov_b32 s65, s9
    s_mov_b32 s66, 0x200000
    s_mov_b32 s67, 0x20000
    s_mov_b32 s68, s16
    s_mov_b32 s69, s17
    s_mov_b32 s70, 0xe00000
    s_mov_b32 s71, 0x20000
    s_mov_b32 s72, s18
    s_mov_b32 s73, s19
    s_mov_b32 s74, 0x1000
    s_mov_b32 s75, 0x20000
    s_mov_b32 s76, s22
    s_mov_b32 s77, s23
    s_mov_b32 s78, 0x400000
    s_mov_b32 s79, 0x20000
    s_mov_b32 s80, s24
    s_mov_b32 s81, s25
    s_mov_b32 s82, 0x100
    s_mov_b32 s83, 0x20000
    s_and_b32 s34, s3, 1
    s_lshr_b32 s38, s3, 1
    s_lshl_b32 s36, s38, 4
    s_sub_u32 s36, s36, 8
    s_lshl_b32 s36, s36, 7
    s_add_u32 s39, s36, 1024
    s_lshl_b32 s36, s34, 2
    v_and_b32 v112, 15, v0
    v_lshrrev_b32 v113, 4, v0
    v_lshrrev_b32 v114, 1, v112
    v_add_u32 v114, 4, v114
    v_and_b32 v114, 7, v114
    v_add_u32 v115, s36, v113
    v_xor_b32 v115, v115, v114
    v_lshlrev_b32 v115, 4, v115
    v_lshl_add_u32 v115, v112, 7, v115
    v_add_u32 v128, s39, v115
    v_and_b32 v116, 3, v0
    v_bfe_u32 v117, v0, 2, 2
    v_lshrrev_b32 v114, 1, v117
    v_lshl_add_u32 v114, v113, 1, v114
    v_add_u32 v114, 4, v114
    v_and_b32 v114, 7, v114
    v_lshrrev_b32 v115, 1, v116
    v_add_u32 v115, s36, v115
    v_xor_b32 v115, v115, v114
    v_lshlrev_b32 v115, 4, v115
    v_and_b32 v118, 1, v116
    v_lshl_add_u32 v115, v118, 3, v115
    v_lshl_add_u32 v118, v113, 2, v117
    v_lshl_add_u32 v115, v118, 7, v115
    v_add_u32 v129, s39, v115
    v_lshlrev_b32 v118, 2, v113
    v_sub_u32 v118, v112, v118
    v_subrev_u32 v119, 0, v118
    v_cmp_gt_u32 s[4:5], 8, v119
    v_add_u32 v119, 16, v118
    v_cmp_gt_u32 s[12:13], 8, v119
    v_subrev_u32 v119, 1, v118
    v_cmp_gt_u32 s[6:7], 8, v119
    v_add_u32 v119, 15, v118
    v_cmp_gt_u32 s[14:15], 8, v119
    v_subrev_u32 v119, 2, v118
    v_cmp_gt_u32 s[8:9], 8, v119
    v_add_u32 v119, 14, v118
    v_cmp_gt_u32 s[16:17], 8, v119
    v_subrev_u32 v119, 3, v118
    v_cmp_gt_u32 s[10:11], 8, v119
    v_add_u32 v119, 13, v118
    v_cmp_gt_u32 s[18:19], 8, v119
    s_lshl_b32 s37, s3, 11
    s_add_u32 s37, s37, 1024
    v_lshrrev_b32 v114, 3, v112
    v_lshlrev_b32 v114, 10, v114
    v_lshl_add_u32 v114, v113, 8, v114
    v_and_b32 v115, 7, v112
    v_lshl_add_u32 v114, v115, 5, v114
    v_add_u32 v130, s37, v114
    v_lshlrev_b32 v114, 4, v0
    v_add_u32 v131, s37, v114
    s_or_b32 s36, s30, s38
    s_cmp_eq_u32 s36, 0
    s_cselect_b64 s[12:13], 0, s[12:13]
    s_cselect_b64 s[14:15], 0, s[14:15]
    s_cselect_b64 s[16:17], 0, s[16:17]
    s_cselect_b64 s[18:19], 0, s[18:19]
    s_lshl_b32 s36, s30, 18
    s_lshl_b32 s37, s31, 1
    s_add_u32 s37, s37, s34
    s_lshl_b32 s37, s37, 13
    s_add_u32 s36, s36, s37
    s_lshl_b32 s37, s38, 11
    s_add_u32 s36, s36, s37
    s_add_u32 s84, s36, 12582912
    v_lshrrev_b32 v250, 4, v0
    v_and_b32 v251, 15, v0
    s_mov_b32 s36, 7168
    v_mul_lo_u32 v253, v250, s36
    v_lshlrev_b32 v252, 1, v250
    v_xor_b32 v252, v252, v251
    v_lshl_add_u32 v252, v252, 4, v253
    v_add_u32 v144, 0, v252
    v_lshlrev_b32 v252, 1, v250
    v_xor_b32 v252, v252, v251
    v_lshl_add_u32 v252, v252, 4, v253
    v_add_u32 v145, 27648, v252
    v_lshlrev_b32 v252, 1, v250
    v_or_b32 v252, 8, v252
    v_xor_b32 v252, v252, v251
    v_lshl_add_u32 v252, v252, 4, v253
    v_add_u32 v146, 55296, v252
    v_lshlrev_b32 v252, 1, v250
    v_or_b32 v252, 8, v252
    v_xor_b32 v252, v252, v251
    v_lshl_add_u32 v252, v252, 4, v253
    v_add_u32 v147, 82944, v252
    v_lshrrev_b32 v250, 4, v0
    v_and_b32 v251, 15, v0
    s_mov_b32 s36, 2048
    v_mul_lo_u32 v253, v250, s36
    v_lshlrev_b32 v252, 1, v250
    v_xor_b32 v252, v252, v251
    v_lshl_add_u32 v252, v252, 4, v253
    v_add_u32 v148, 0, v252
    v_lshlrev_b32 v252, 1, v250
    v_or_b32 v252, 8, v252
    v_xor_b32 v252, v252, v251
    v_lshl_add_u32 v252, v252, 4, v253
    v_add_u32 v149, 7168, v252
    v_lshlrev_b32 v252, 1, v250
    v_xor_b32 v252, v252, v251
    v_lshl_add_u32 v252, v252, 4, v253
    v_add_u32 v150, 14336, v252
    v_lshlrev_b32 v252, 1, v250
    v_or_b32 v252, 8, v252
    v_xor_b32 v252, v252, v251
    v_lshl_add_u32 v252, v252, 4, v253
    v_add_u32 v151, 21504, v252
    v_lshrrev_b32 v250, 4, v0
    v_and_b32 v251, 15, v0
    s_mov_b32 s36, 4096
    v_mul_lo_u32 v253, v250, s36
    v_lshlrev_b32 v252, 1, v250
    v_xor_b32 v252, v252, v251
    v_lshl_add_u32 v252, v252, 4, v253
    v_add_u32 v152, 0, v252
    v_lshlrev_b32 v252, 1, v250
    v_or_b32 v252, 8, v252
    v_xor_b32 v252, v252, v251
    v_lshl_add_u32 v252, v252, 4, v253
    v_add_u32 v153, 15360, v252
    v_lshlrev_b32 v252, 1, v250
    v_xor_b32 v252, v252, v251
    v_lshl_add_u32 v252, v252, 4, v253
    v_add_u32 v154, 30720, v252
    v_lshlrev_b32 v252, 1, v250
    v_or_b32 v252, 8, v252
    v_xor_b32 v252, v252, v251
    v_lshl_add_u32 v252, v252, 4, v253
    v_add_u32 v155, 46080, v252
    v_lshlrev_b32 v156, 4, v0
    s_sub_u32 s34, s3, 4
    s_lshl_b32 s85, s34, 12
    v_lshlrev_b32 v124, 7, v0
    v_lshlrev_b32 v121, 2, v0
    v_and_b32 v123, 7, v0
    v_lshlrev_b32 v123, 2, v123
    v_add_u32 v123, 64, v123
    v_min_u32 v122, 13, v0
    v_lshlrev_b32 v122, 2, v122
    s_and_b32 s30, s28, 1
    s_lshl_b32 s30, s30, 2
    s_and_b32 s32, s29, 3
    s_add_u32 s30, s30, s32
    s_lshr_b32 s31, s28, 1
    s_mul_i32 s31, s31, 7
    s_lshr_b32 s33, s29, 2
    s_add_u32 s31, s31, s33
    s_mul_i32 s86, s34, 114688
    s_lshl_b32 s36, s31, 8
    s_add_u32 s86, s86, s36
    s_lshl_b32 s87, s30, 19
    s_add_u32 s87, s87, s85
    s_mul_i32 s35, s32, 2
    s_mul_i32 s36, s33, 1
    s_add_u32 s35, s35, s36
    s_mov_b32 s38, 65536
    s_mov_b32 s39, 0
    s_mov_b32 s98, 0
    s_barrier
L_l1loop:
    s_waitcnt vmcnt(11)
    s_barrier
    s_cmp_lg_u32 s95, 15
    s_cbranch_scc1 L_l1np
    s_cmp_lg_u32 s34, 0
    s_cbranch_scc1 L_l1np
    buffer_load_dword v120, v121, s[80:83], s98 offen sc0 sc1
L_l1np:
    s_add_u32 s96, s95, s93
    s_and_b32 s96, s96, 3
    s_andn2_b32 s36, s95, 3
    s_or_b32 s96, s96, s36
    s_lshl_b32 s0, s96, 7
    s_mul_i32 s1, s96, 393216
    s_add_u32 s1, s1, s92
    s_add_u32 s97, s94, s90
    s_add_u32 m0, s97, 0
    s_nop 0
    buffer_load_dwordx4 v2, s[44:47], s0 offen lds
    s_add_u32 m0, s97, 1024
    s_nop 0
    buffer_load_dwordx4 v3, s[44:47], s0 offen lds
    s_add_u32 m0, s97, 2048
    s_nop 0
    buffer_load_dwordx4 v4, s[44:47], s0 offen lds
    s_add_u32 m0, s97, 3072
    s_nop 0
    buffer_load_dwordx4 v5, s[44:47], s0 offen lds
    s_add_u32 m0, s97, 4096
    s_mov_b32 exec_hi, 0
    buffer_load_dwordx4 v6, s[44:47], s0 offen lds
    s_mov_b64 exec, -1
    s_add_u32 s97, s94, s91
    s_add_u32 m0, s97, 0
    s_nop 0
    buffer_load_dwordx4 v7, s[48:51], s1 offen lds
    s_add_u32 m0, s97, 1024
    s_nop 0
    buffer_load_dwordx4 v8, s[48:51], s1 offen lds
    s_add_u32 m0, s97, 2048
    s_nop 0
    buffer_load_dwordx4 v9, s[48:51], s1 offen lds
    s_add_u32 m0, s97, 3072
    s_nop 0
    buffer_load_dwordx4 v10, s[48:51], s1 offen lds
    s_add_u32 m0, s97, 4096
    s_nop 0
    buffer_load_dwordx4 v11, s[48:51], s1 offen lds
    s_add_u32 m0, s97, 5120
    s_nop 0
    buffer_load_dwordx4 v12, s[48:51], s1 offen lds
    s_add_u32 s94, s94, 43008
    s_cmp_eq_u32 s94, 129024
    s_cselect_b32 s94, 0, s94
    s_add_u32 s95, s95, 1
    s_cmp_lt_u32 s95, 16
    s_cbranch_scc1 L_l1loop
    s_waitcnt vmcnt(11)
    s_barrier
    s_waitcnt vmcnt(0)
    s_cmp_lg_u32 s34, 0
    s_cbranch_scc1 L_pln_ok
    s_mov_b32 s101, 0
    v_cmp_ne_u32 vcc, 16843009, v120
    s_cbranch_vccz L_pln_ok
L_pln_p:
    buffer_load_dword v120, v121, s[80:83], s98 offen sc0 sc1
    s_add_u32 s101, s101, 1
    s_waitcnt vmcnt(0)
    v_cmp_ne_u32 vcc, 16843009, v120
    s_cbranch_vccz L_pln_ok
    s_sleep 2
    s_cmp_lt_u32 s101, 32768
    s_cbranch_scc1 L_pln_p
L_pln_ok:
    s_barrier
    s_cmp_ge_u32 s29, 28
    s_cbranch_scc1 L_l_idle
    s_add_u32 s0, s39, s35
    s_and_b32 s0, s0, 7
    s_andn2_b32 s36, s39, 7
    s_or_b32 s0, s0, s36
    s_mul_i32 s32, s0, 458752
    s_add_u32 s32, s32, s86
    s_lshl_b32 s33, s0, 14
    s_add_u32 s33, s33, s87
    s_add_u32 m0, s38, s85
    s_add_u32 s1, s38, 16384
    buffer_load_dwordx4 v144, s[56:59], s32 offen offset:0 lds
    buffer_load_dwordx4 v145, s[56:59], s32 offen offset:1024 lds
    buffer_load_dwordx4 v146, s[56:59], s32 offen offset:2048 lds
    buffer_load_dwordx4 v147, s[56:59], s32 offen offset:3072 lds
    s_add_u32 m0, s1, s85
    s_add_u32 s38, s38, 32768
    buffer_load_dwordx4 v156, s[40:43], s33 offen offset:0 sc1 lds
    buffer_load_dwordx4 v156, s[40:43], s33 offen offset:1024 sc1 lds
    buffer_load_dwordx4 v156, s[40:43], s33 offen offset:2048 sc1 lds
    buffer_load_dwordx4 v156, s[40:43], s33 offen offset:3072 sc1 lds
    s_cmp_eq_u32 s38, 163840
    s_cselect_b32 s38, 0, s38
    s_add_u32 s39, s39, 1
    s_barrier
    s_add_u32 s0, s39, s35
    s_and_b32 s0, s0, 7
    s_andn2_b32 s36, s39, 7
    s_or_b32 s0, s0, s36
    s_mul_i32 s32, s0, 458752
    s_add_u32 s32, s32, s86
    s_lshl_b32 s33, s0, 14
    s_add_u32 s33, s33, s87
    s_add_u32 m0, s38, s85
    s_add_u32 s1, s38, 16384
    buffer_load_dwordx4 v144, s[56:59], s32 offen offset:0 lds
    buffer_load_dwordx4 v145, s[56:59], s32 offen offset:1024 lds
    buffer_load_dwordx4 v146, s[56:59], s32 offen offset:2048 lds
    buffer_load_dwordx4 v147, s[56:59], s32 offen offset:3072 lds
    s_add_u32 m0, s1, s85
    s_add_u32 s38, s38, 32768
    buffer_load_dwordx4 v156, s[40:43], s33 offen offset:0 sc1 lds
    buffer_load_dwordx4 v156, s[40:43], s33 offen offset:1024 sc1 lds
    buffer_load_dwordx4 v156, s[40:43], s33 offen offset:2048 sc1 lds
    buffer_load_dwordx4 v156, s[40:43], s33 offen offset:3072 sc1 lds
    s_cmp_eq_u32 s38, 163840
    s_cselect_b32 s38, 0, s38
    s_add_u32 s39, s39, 1
    s_barrier
    v_xor_b32 v8, 64, v128
    v_xor_b32 v9, 32, v129
    v_xor_b32 v10, 64, v129
    v_xor_b32 v11, 96, v129
    ds_read_b128 v[24:27], v128 offset:18432
    ds_read_b128 v[28:31], v128 offset:20480
    ds_read_b128 v[16:19], v128 offset:2048
    ds_read_b128 v[32:35], v8 offset:27648
    ds_read_b128 v[36:39], v8 offset:29696
    ds_read_b128 v[20:23], v8 offset:11264
    ds_read_b64_tr_b16 v[96:97], v129 offset:36864
    ds_read_b64_tr_b16 v[98:99], v129 offset:38912
    ds_read_b64_tr_b16 v[100:101], v9 offset:36864
    ds_read_b64_tr_b16 v[102:103], v9 offset:38912
    ds_read_b64_tr_b16 v[104:105], v10 offset:46080
    ds_read_b64_tr_b16 v[106:107], v10 offset:48128
    ds_read_b64_tr_b16 v[108:109], v11 offset:46080
    ds_read_b64_tr_b16 v[110:111], v11 offset:48128
    v_mov_b32 v12, 0xff800000
    v_mov_b32 v13, 0x3e8293ee
    s_waitcnt lgkmcnt(8)
    v_mfma_f32_16x16x32_bf16 v[48:51], v[24:27], v[16:19], 0
    v_mfma_f32_16x16x32_bf16 v[52:55], v[28:31], v[16:19], 0
    v_mfma_f32_16x16x32_bf16 v[56:59], v[32:35], v[20:23], 0
    v_mfma_f32_16x16x32_bf16 v[60:63], v[36:39], v[20:23], 0
    s_waitcnt lgkmcnt(0)
    s_barrier
    s_nop 5
    v_cndmask_b32 v48, v12, v48, s[12:13]
    v_cndmask_b32 v52, v12, v52, s[4:5]
    v_cndmask_b32 v49, v12, v49, s[14:15]
    v_cndmask_b32 v53, v12, v53, s[6:7]
    v_cndmask_b32 v50, v12, v50, s[16:17]
    v_cndmask_b32 v54, v12, v54, s[8:9]
    v_cndmask_b32 v51, v12, v51, s[18:19]
    v_cndmask_b32 v55, v12, v55, s[10:11]
    v_cndmask_b32 v56, v12, v56, s[12:13]
    v_cndmask_b32 v60, v12, v60, s[4:5]
    v_cndmask_b32 v57, v12, v57, s[14:15]
    v_cndmask_b32 v61, v12, v61, s[6:7]
    v_cndmask_b32 v58, v12, v58, s[16:17]
    v_cndmask_b32 v62, v12, v62, s[8:9]
    v_cndmask_b32 v59, v12, v59, s[18:19]
    v_cndmask_b32 v63, v12, v63, s[10:11]
    v_max3_f32 v64, v48, v49, v50
    v_max3_f32 v64, v64, v51, v52
    v_max3_f32 v64, v64, v53, v54
    v_max_f32 v64, v64, v55
    v_max3_f32 v65, v56, v57, v58
    v_max3_f32 v65, v65, v59, v60
    v_max3_f32 v65, v65, v61, v62
    v_max_f32 v65, v65, v63
    v_mov_b32 v66, v64
    v_mov_b32 v67, v65
    s_nop 1
    v_permlane16_swap_b32 v64, v66
    v_permlane16_swap_b32 v65, v67
    s_nop 1
    v_max_f32 v64, v64, v66
    v_max_f32 v65, v65, v67
    v_mov_b32 v66, v64
    v_mov_b32 v67, v65
    s_nop 1
    v_permlane32_swap_b32 v64, v66
    v_permlane32_swap_b32 v65, v67
    s_nop 1
    v_max_f32 v64, v64, v66
    v_max_f32 v65, v65, v67
    v_mul_f32 v64, v64, v13
    v_mul_f32 v65, v65, v13
    v_fma_f32 v48, v48, v13, -v64
    v_fma_f32 v49, v49, v13, -v64
    v_fma_f32 v50, v50, v13, -v64
    v_fma_f32 v51, v51, v13, -v64
    v_fma_f32 v52, v52, v13, -v64
    v_fma_f32 v53, v53, v13, -v64
    v_fma_f32 v54, v54, v13, -v64
    v_fma_f32 v55, v55, v13, -v64
    v_exp_f32 v48, v48
    v_exp_f32 v49, v49
    v_exp_f32 v50, v50
    v_exp_f32 v51, v51
    v_exp_f32 v52, v52
    v_exp_f32 v53, v53
    v_exp_f32 v54, v54
    v_exp_f32 v55, v55
    v_fma_f32 v56, v56, v13, -v65
    v_fma_f32 v57, v57, v13, -v65
    v_fma_f32 v58, v58, v13, -v65
    v_fma_f32 v59, v59, v13, -v65
    v_fma_f32 v60, v60, v13, -v65
    v_fma_f32 v61, v61, v13, -v65
    v_fma_f32 v62, v62, v13, -v65
    v_fma_f32 v63, v63, v13, -v65
    v_exp_f32 v56, v56
    v_exp_f32 v57, v57
    v_exp_f32 v58, v58
    v_exp_f32 v59, v59
    v_exp_f32 v60, v60
    v_exp_f32 v61, v61
    v_exp_f32 v62, v62
    v_exp_f32 v63, v63
    v_add_f32 v68, v48, v49
    v_add_f32 v68, v68, v50
    v_add_f32 v68, v68, v51
    v_add_f32 v68, v68, v52
    v_add_f32 v68, v68, v53
    v_add_f32 v68, v68, v54
    v_add_f32 v68, v68, v55
    v_add_f32 v69, v56, v57
    v_add_f32 v69, v69, v58
    v_add_f32 v69, v69, v59
    v_add_f32 v69, v69, v60
    v_add_f32 v69, v69, v61
    v_add_f32 v69, v69, v62
    v_add_f32 v69, v69, v63
    v_mov_b32 v66, v68
    v_mov_b32 v67, v69
    s_nop 1
    v_permlane16_swap_b32 v68, v66
    v_permlane16_swap_b32 v69, v67
    s_nop 1
    v_add_f32 v68, v68, v66
    v_add_f32 v69, v69, v67
    v_mov_b32 v66, v68
    v_mov_b32 v67, v69
    s_nop 1
    v_permlane32_swap_b32 v68, v66
    v_permlane32_swap_b32 v69, v67
    s_nop 1
    v_add_f32 v68, v68, v66
    v_add_f32 v69, v69, v67
    v_rcp_f32 v68, v68
    v_rcp_f32 v69, v69
    s_nop 0
    v_mul_f32 v48, v48, v68
    v_mul_f32 v49, v49, v68
    v_mul_f32 v50, v50, v68
    v_mul_f32 v51, v51, v68
    v_mul_f32 v52, v52, v68
    v_mul_f32 v53, v53, v68
    v_mul_f32 v54, v54, v68
    v_mul_f32 v55, v55, v68
    v_cvt_pk_bf16_f32 v72, v48, v49
    v_cvt_pk_bf16_f32 v73, v50, v51
    v_cvt_pk_bf16_f32 v74, v52, v53
    v_cvt_pk_bf16_f32 v75, v54, v55
    v_mul_f32 v56, v56, v69
    v_mul_f32 v57, v57, v69
    v_mul_f32 v58, v58, v69
    v_mul_f32 v59, v59, v69
    v_mul_f32 v60, v60, v69
    v_mul_f32 v61, v61, v69
    v_mul_f32 v62, v62, v69
    v_mul_f32 v63, v63, v69
    v_cvt_pk_bf16_f32 v76, v56, v57
    v_cvt_pk_bf16_f32 v77, v58, v59
    v_cvt_pk_bf16_f32 v78, v60, v61
    v_cvt_pk_bf16_f32 v79, v62, v63
    s_nop 1
    v_mfma_f32_16x16x32_bf16 v[80:83], v[96:99], v[72:75], 0
    v_mfma_f32_16x16x32_bf16 v[84:87], v[100:103], v[72:75], 0
    v_mfma_f32_16x16x32_bf16 v[88:91], v[104:107], v[76:79], 0
    v_mfma_f32_16x16x32_bf16 v[92:95], v[108:111], v[76:79], 0
    v_lshlrev_b32 v8, 4, v0
    s_nop 6
    v_cvt_pk_bf16_f32 v48, v80, v81
    v_cvt_pk_bf16_f32 v49, v82, v83
    v_cvt_pk_bf16_f32 v50, v84, v85
    v_cvt_pk_bf16_f32 v51, v86, v87
    ds_write_b128 v130, v[48:51] offset:0
    v_cvt_pk_bf16_f32 v52, v88, v89
    v_cvt_pk_bf16_f32 v53, v90, v91
    v_cvt_pk_bf16_f32 v54, v92, v93
    v_cvt_pk_bf16_f32 v55, v94, v95
    ds_write_b128 v130, v[52:55] offset:16
    s_waitcnt lgkmcnt(0)
    ds_read_b128 v[56:59], v131 offset:0
    ds_read_b128 v[60:63], v131 offset:1024
    s_waitcnt lgkmcnt(1)
    buffer_store_dwordx4 v[56:59], v8, s[40:43], s84 offen offset:0 sc0 sc1
    s_waitcnt lgkmcnt(0)
    buffer_store_dwordx4 v[60:63], v8, s[40:43], s84 offen offset:1024 sc0 sc1
    s_add_u32 s0, s39, s35
    s_and_b32 s0, s0, 7
    s_andn2_b32 s36, s39, 7
    s_or_b32 s0, s0, s36
    s_mul_i32 s32, s0, 458752
    s_add_u32 s32, s32, s86
    s_lshl_b32 s33, s0, 14
    s_add_u32 s33, s33, s87
    s_add_u32 m0, s38, s85
    s_add_u32 s1, s38, 16384
    buffer_load_dwordx4 v144, s[56:59], s32 offen offset:0 lds
    buffer_load_dwordx4 v145, s[56:59], s32 offen offset:1024 lds
    buffer_load_dwordx4 v146, s[56:59], s32 offen offset:2048 lds
    buffer_load_dwordx4 v147, s[56:59], s32 offen offset:3072 lds
    s_add_u32 m0, s1, s85
    s_add_u32 s38, s38, 32768
    buffer_load_dwordx4 v156, s[40:43], s33 offen offset:0 sc1 lds
    buffer_load_dwordx4 v156, s[40:43], s33 offen offset:1024 sc1 lds
    buffer_load_dwordx4 v156, s[40:43], s33 offen offset:2048 sc1 lds
    buffer_load_dwordx4 v156, s[40:43], s33 offen offset:3072 sc1 lds
    s_cmp_eq_u32 s38, 163840
    s_cselect_b32 s38, 0, s38
    s_add_u32 s39, s39, 1
    s_waitcnt vmcnt(18)
    s_barrier
L_l2pro2:
    s_add_u32 s0, s39, s35
    s_and_b32 s0, s0, 7
    s_andn2_b32 s36, s39, 7
    s_or_b32 s0, s0, s36
    s_mul_i32 s32, s0, 458752
    s_add_u32 s32, s32, s86
    s_lshl_b32 s33, s0, 14
    s_add_u32 s33, s33, s87
    s_add_u32 m0, s38, s85
    s_add_u32 s1, s38, 16384
    buffer_load_dwordx4 v144, s[56:59], s32 offen offset:0 lds
    buffer_load_dwordx4 v145, s[56:59], s32 offen offset:1024 lds
    buffer_load_dwordx4 v146, s[56:59], s32 offen offset:2048 lds
    buffer_load_dwordx4 v147, s[56:59], s32 offen offset:3072 lds
    s_add_u32 m0, s1, s85
    s_add_u32 s38, s38, 32768
    buffer_load_dwordx4 v156, s[40:43], s33 offen offset:0 sc1 lds
    buffer_load_dwordx4 v156, s[40:43], s33 offen offset:1024 sc1 lds
    buffer_load_dwordx4 v156, s[40:43], s33 offen offset:2048 sc1 lds
    buffer_load_dwordx4 v156, s[40:43], s33 offen offset:3072 sc1 lds
    s_cmp_eq_u32 s38, 163840
    s_cselect_b32 s38, 0, s38
    s_add_u32 s39, s39, 1
    s_cmp_lt_u32 s39, 5
    s_cbranch_scc1 L_l2pro2
    s_waitcnt vmcnt(26)
    s_barrier
    s_branch L_l2iss
L_l2loop:
    s_waitcnt vmcnt(24)
    s_barrier
    s_cmp_lg_u32 s39, 24
    s_cbranch_scc1 L_l2iss
    s_and_b32 s8, s28, 1
    s_bfe_u32 s4, s28, 0x10001
    s_lshl_b32 s4, s4, 3
    s_and_b32 s6, s29, 7
    s_add_u32 s4, s4, s6
    s_lshr_b32 s5, s28, 2
    s_lshl_b32 s5, s5, 2
    s_lshr_b32 s7, s29, 3
    s_add_u32 s5, s5, s7
    s_lshl_b32 s10, s34, 15
    s_lshl_b32 s36, s5, 8
    s_add_u32 s10, s10, s36
    s_lshl_b32 s36, s8, 20
    s_add_u32 s10, s10, s36
    s_lshl_b32 s11, s4, 18
    s_add_u32 s11, s11, s85
    s_lshl_b32 s36, s8, 17
    s_add_u32 s11, s11, s36
    s_add_u32 s11, s11, 12582912
    s_mul_i32 s12, s5, 917504
    s_add_u32 s12, s12, s85
    s_mul_i32 s36, s8, 458752
    s_add_u32 s12, s12, s36
    s_add_u32 s12, s12, 4194304
    s_lshl_b32 s13, s34, 16
    s_lshl_b32 s36, s4, 8
    s_add_u32 s13, s13, s36
    s_mul_i32 s36, s8, 7340032
    s_add_u32 s13, s13, s36
    s_mul_i32 s14, s6, 1
    s_mul_i32 s36, s7, 1
    s_add_u32 s14, s14, s36
    s_lshl_b32 s15, s2, 7
    s_add_u32 s15, s15, 27328512
    s_mov_b32 s17, 0
    s_cmp_lg_u32 s34, 0
    s_cbranch_scc1 L_l2iss
    buffer_load_dword v120, v123, s[40:43], s15 offen sc0 sc1
L_l2iss:
    s_add_u32 s0, s39, s35
    s_and_b32 s0, s0, 7
    s_andn2_b32 s36, s39, 7
    s_or_b32 s0, s0, s36
    s_mul_i32 s32, s0, 458752
    s_add_u32 s32, s32, s86
    s_lshl_b32 s33, s0, 14
    s_add_u32 s33, s33, s87
    s_add_u32 m0, s38, s85
    s_add_u32 s1, s38, 16384
    buffer_load_dwordx4 v144, s[56:59], s32 offen offset:0 lds
    buffer_load_dwordx4 v145, s[56:59], s32 offen offset:1024 lds
    buffer_load_dwordx4 v146, s[56:59], s32 offen offset:2048 lds
    buffer_load_dwordx4 v147, s[56:59], s32 offen offset:3072 lds
    s_add_u32 m0, s1, s85
    s_add_u32 s38, s38, 32768
    buffer_load_dwordx4 v156, s[40:43], s33 offen offset:0 sc1 lds
    buffer_load_dwordx4 v156, s[40:43], s33 offen offset:1024 sc1 lds
    buffer_load_dwordx4 v156, s[40:43], s33 offen offset:2048 sc1 lds
    buffer_load_dwordx4 v156, s[40:43], s33 offen offset:3072 sc1 lds
    s_cmp_eq_u32 s38, 163840
    s_cselect_b32 s38, 0, s38
    s_add_u32 s39, s39, 1
    s_cmp_lt_u32 s39, 32
    s_cbranch_scc1 L_l2loop
    s_cmp_lg_u32 s34, 0
    s_cbranch_scc1 L_po_ok
    s_mov_b32 s101, 0
    v_cmp_ne_u32 vcc, 1, v120
    s_cbranch_vccz L_po_ok
L_po_p:
    buffer_load_dword v120, v123, s[40:43], s15 offen sc0 sc1
    s_add_u32 s101, s101, 1
    s_waitcnt vmcnt(0)
    v_cmp_ne_u32 vcc, 1, v120
    s_cbranch_vccz L_po_ok
    s_sleep 8
    s_cmp_lt_u32 s101, 32768
    s_cbranch_scc1 L_po_p
L_po_ok:
    s_mov_b32 s25, 4
    s_branch L_l3aloop
L_l_idle:
    s_barrier
    s_barrier
    v_xor_b32 v8, 64, v128
    v_xor_b32 v9, 32, v129
    v_xor_b32 v10, 64, v129
    v_xor_b32 v11, 96, v129
    ds_read_b128 v[24:27], v128 offset:18432
    ds_read_b128 v[28:31], v128 offset:20480
    ds_read_b128 v[16:19], v128 offset:2048
    ds_read_b128 v[32:35], v8 offset:27648
    ds_read_b128 v[36:39], v8 offset:29696
    ds_read_b128 v[20:23], v8 offset:11264
    ds_read_b64_tr_b16 v[96:97], v129 offset:36864
    ds_read_b64_tr_b16 v[98:99], v129 offset:38912
    ds_read_b64_tr_b16 v[100:101], v9 offset:36864
    ds_read_b64_tr_b16 v[102:103], v9 offset:38912
    ds_read_b64_tr_b16 v[104:105], v10 offset:46080
    ds_read_b64_tr_b16 v[106:107], v10 offset:48128
    ds_read_b64_tr_b16 v[108:109], v11 offset:46080
    ds_read_b64_tr_b16 v[110:111], v11 offset:48128
    v_mov_b32 v12, 0xff800000
    v_mov_b32 v13, 0x3e8293ee
    s_waitcnt lgkmcnt(8)
    v_mfma_f32_16x16x32_bf16 v[48:51], v[24:27], v[16:19], 0
    v_mfma_f32_16x16x32_bf16 v[52:55], v[28:31], v[16:19], 0
    v_mfma_f32_16x16x32_bf16 v[56:59], v[32:35], v[20:23], 0
    v_mfma_f32_16x16x32_bf16 v[60:63], v[36:39], v[20:23], 0
    s_waitcnt lgkmcnt(0)
    s_barrier
    s_nop 5
    v_cndmask_b32 v48, v12, v48, s[12:13]
    v_cndmask_b32 v52, v12, v52, s[4:5]
    v_cndmask_b32 v49, v12, v49, s[14:15]
    v_cndmask_b32 v53, v12, v53, s[6:7]
    v_cndmask_b32 v50, v12, v50, s[16:17]
    v_cndmask_b32 v54, v12, v54, s[8:9]
    v_cndmask_b32 v51, v12, v51, s[18:19]
    v_cndmask_b32 v55, v12, v55, s[10:11]
    v_cndmask_b32 v56, v12, v56, s[12:13]
    v_cndmask_b32 v60, v12, v60, s[4:5]
    v_cndmask_b32 v57, v12, v57, s[14:15]
    v_cndmask_b32 v61, v12, v61, s[6:7]
    v_cndmask_b32 v58, v12, v58, s[16:17]
    v_cndmask_b32 v62, v12, v62, s[8:9]
    v_cndmask_b32 v59, v12, v59, s[18:19]
    v_cndmask_b32 v63, v12, v63, s[10:11]
    v_max3_f32 v64, v48, v49, v50
    v_max3_f32 v64, v64, v51, v52
    v_max3_f32 v64, v64, v53, v54
    v_max_f32 v64, v64, v55
    v_max3_f32 v65, v56, v57, v58
    v_max3_f32 v65, v65, v59, v60
    v_max3_f32 v65, v65, v61, v62
    v_max_f32 v65, v65, v63
    v_mov_b32 v66, v64
    v_mov_b32 v67, v65
    s_nop 1
    v_permlane16_swap_b32 v64, v66
    v_permlane16_swap_b32 v65, v67
    s_nop 1
    v_max_f32 v64, v64, v66
    v_max_f32 v65, v65, v67
    v_mov_b32 v66, v64
    v_mov_b32 v67, v65
    s_nop 1
    v_permlane32_swap_b32 v64, v66
    v_permlane32_swap_b32 v65, v67
    s_nop 1
    v_max_f32 v64, v64, v66
    v_max_f32 v65, v65, v67
    v_mul_f32 v64, v64, v13
    v_mul_f32 v65, v65, v13
    v_fma_f32 v48, v48, v13, -v64
    v_fma_f32 v49, v49, v13, -v64
    v_fma_f32 v50, v50, v13, -v64
    v_fma_f32 v51, v51, v13, -v64
    v_fma_f32 v52, v52, v13, -v64
    v_fma_f32 v53, v53, v13, -v64
    v_fma_f32 v54, v54, v13, -v64
    v_fma_f32 v55, v55, v13, -v64
    v_exp_f32 v48, v48
    v_exp_f32 v49, v49
    v_exp_f32 v50, v50
    v_exp_f32 v51, v51
    v_exp_f32 v52, v52
    v_exp_f32 v53, v53
    v_exp_f32 v54, v54
    v_exp_f32 v55, v55
    v_fma_f32 v56, v56, v13, -v65
    v_fma_f32 v57, v57, v13, -v65
    v_fma_f32 v58, v58, v13, -v65
    v_fma_f32 v59, v59, v13, -v65
    v_fma_f32 v60, v60, v13, -v65
    v_fma_f32 v61, v61, v13, -v65
    v_fma_f32 v62, v62, v13, -v65
    v_fma_f32 v63, v63, v13, -v65
    v_exp_f32 v56, v56
    v_exp_f32 v57, v57
    v_exp_f32 v58, v58
    v_exp_f32 v59, v59
    v_exp_f32 v60, v60
    v_exp_f32 v61, v61
    v_exp_f32 v62, v62
    v_exp_f32 v63, v63
    v_add_f32 v68, v48, v49
    v_add_f32 v68, v68, v50
    v_add_f32 v68, v68, v51
    v_add_f32 v68, v68, v52
    v_add_f32 v68, v68, v53
    v_add_f32 v68, v68, v54
    v_add_f32 v68, v68, v55
    v_add_f32 v69, v56, v57
    v_add_f32 v69, v69, v58
    v_add_f32 v69, v69, v59
    v_add_f32 v69, v69, v60
    v_add_f32 v69, v69, v61
    v_add_f32 v69, v69, v62
    v_add_f32 v69, v69, v63
    v_mov_b32 v66, v68
    v_mov_b32 v67, v69
    s_nop 1
    v_permlane16_swap_b32 v68, v66
    v_permlane16_swap_b32 v69, v67
    s_nop 1
    v_add_f32 v68, v68, v66
    v_add_f32 v69, v69, v67
    v_mov_b32 v66, v68
    v_mov_b32 v67, v69
    s_nop 1
    v_permlane32_swap_b32 v68, v66
    v_permlane32_swap_b32 v69, v67
    s_nop 1
    v_add_f32 v68, v68, v66
    v_add_f32 v69, v69, v67
    v_rcp_f32 v68, v68
    v_rcp_f32 v69, v69
    s_nop 0
    v_mul_f32 v48, v48, v68
    v_mul_f32 v49, v49, v68
    v_mul_f32 v50, v50, v68
    v_mul_f32 v51, v51, v68
    v_mul_f32 v52, v52, v68
    v_mul_f32 v53, v53, v68
    v_mul_f32 v54, v54, v68
    v_mul_f32 v55, v55, v68
    v_cvt_pk_bf16_f32 v72, v48, v49
    v_cvt_pk_bf16_f32 v73, v50, v51
    v_cvt_pk_bf16_f32 v74, v52, v53
    v_cvt_pk_bf16_f32 v75, v54, v55
    v_mul_f32 v56, v56, v69
    v_mul_f32 v57, v57, v69
    v_mul_f32 v58, v58, v69
    v_mul_f32 v59, v59, v69
    v_mul_f32 v60, v60, v69
    v_mul_f32 v61, v61, v69
    v_mul_f32 v62, v62, v69
    v_mul_f32 v63, v63, v69
    v_cvt_pk_bf16_f32 v76, v56, v57
    v_cvt_pk_bf16_f32 v77, v58, v59
    v_cvt_pk_bf16_f32 v78, v60, v61
    v_cvt_pk_bf16_f32 v79, v62, v63
    s_nop 1
    v_mfma_f32_16x16x32_bf16 v[80:83], v[96:99], v[72:75], 0
    v_mfma_f32_16x16x32_bf16 v[84:87], v[100:103], v[72:75], 0
    v_mfma_f32_16x16x32_bf16 v[88:91], v[104:107], v[76:79], 0
    v_mfma_f32_16x16x32_bf16 v[92:95], v[108:111], v[76:79], 0
    v_lshlrev_b32 v8, 4, v0
    s_nop 6
    v_cvt_pk_bf16_f32 v48, v80, v81
    v_cvt_pk_bf16_f32 v49, v82, v83
    v_cvt_pk_bf16_f32 v50, v84, v85
    v_cvt_pk_bf16_f32 v51, v86, v87
    ds_write_b128 v130, v[48:51] offset:0
    v_cvt_pk_bf16_f32 v52, v88, v89
    v_cvt_pk_bf16_f32 v53, v90, v91
    v_cvt_pk_bf16_f32 v54, v92, v93
    v_cvt_pk_bf16_f32 v55, v94, v95
    ds_write_b128 v130, v[52:55] offset:16
    s_waitcnt lgkmcnt(0)
    ds_read_b128 v[56:59], v131 offset:0
    ds_read_b128 v[60:63], v131 offset:1024
    s_waitcnt lgkmcnt(1)
    buffer_store_dwordx4 v[56:59], v8, s[40:43], s84 offen offset:0 sc0 sc1
    s_waitcnt lgkmcnt(0)
    buffer_store_dwordx4 v[60:63], v8, s[40:43], s84 offen offset:1024 sc0 sc1
    s_and_b32 s8, s28, 1
    s_bfe_u32 s4, s28, 0x10001
    s_lshl_b32 s4, s4, 3
    s_and_b32 s6, s29, 7
    s_add_u32 s4, s4, s6
    s_lshr_b32 s5, s28, 2
    s_lshl_b32 s5, s5, 2
    s_lshr_b32 s7, s29, 3
    s_add_u32 s5, s5, s7
    s_lshl_b32 s10, s34, 15
    s_lshl_b32 s36, s5, 8
    s_add_u32 s10, s10, s36
    s_lshl_b32 s36, s8, 20
    s_add_u32 s10, s10, s36
    s_lshl_b32 s11, s4, 18
    s_add_u32 s11, s11, s85
    s_lshl_b32 s36, s8, 17
    s_add_u32 s11, s11, s36
    s_add_u32 s11, s11, 12582912
    s_mul_i32 s12, s5, 917504
    s_add_u32 s12, s12, s85
    s_mul_i32 s36, s8, 458752
    s_add_u32 s12, s12, s36
    s_add_u32 s12, s12, 4194304
    s_lshl_b32 s13, s34, 16
    s_lshl_b32 s36, s4, 8
    s_add_u32 s13, s13, s36
    s_mul_i32 s36, s8, 7340032
    s_add_u32 s13, s13, s36
    s_mul_i32 s14, s6, 1
    s_mul_i32 s36, s7, 1
    s_add_u32 s14, s14, s36
    s_lshl_b32 s15, s2, 7
    s_add_u32 s15, s15, 27328512
    s_mov_b32 s17, 0
    s_waitcnt vmcnt(0)
    s_barrier
    s_cmp_lg_u32 s34, 0
    s_cbranch_scc1 L_po2_ok
    s_mov_b32 s101, 0
L_po2_p:
    buffer_load_dword v120, v123, s[40:43], s15 offen sc0 sc1
    s_add_u32 s101, s101, 1
    s_waitcnt vmcnt(0)
    v_cmp_ne_u32 vcc, 1, v120
    s_cbranch_vccz L_po2_ok
    s_sleep 8
    s_cmp_lt_u32 s101, 32768
    s_cbranch_scc1 L_po2_p
L_po2_ok:
    s_mov_b32 s25, 99
    s_barrier
L_l3pro:
    s_add_u32 s0, s17, s14
    s_and_b32 s0, s0, 3
    s_andn2_b32 s36, s17, 3
    s_or_b32 s0, s0, s36
    s_lshl_b32 s32, s0, 17
    s_add_u32 s32, s32, s10
    s_lshl_b32 s33, s0, 14
    s_add_u32 s33, s33, s11
    s_add_u32 m0, s38, s85
    s_add_u32 s1, s38, 16384
    buffer_load_dwordx4 v148, s[64:67], s32 offen offset:0 lds
    buffer_load_dwordx4 v149, s[64:67], s32 offen offset:1024 lds
    buffer_load_dwordx4 v150, s[64:67], s32 offen offset:2048 lds
    buffer_load_dwordx4 v151, s[64:67], s32 offen offset:3072 lds
    s_add_u32 m0, s1, s85
    s_add_u32 s38, s38, 32768
    buffer_load_dwordx4 v156, s[40:43], s33 offen offset:0 sc1 lds
    buffer_load_dwordx4 v156, s[40:43], s33 offen offset:1024 sc1 lds
    buffer_load_dwordx4 v156, s[40:43], s33 offen offset:2048 sc1 lds
    buffer_load_dwordx4 v156, s[40:43], s33 offen offset:3072 sc1 lds
    s_cmp_eq_u32 s38, 163840
    s_cselect_b32 s38, 0, s38
    s_add_u32 s17, s17, 1
    s_cmp_lt_u32 s17, 4
    s_cbranch_scc1 L_l3pro
L_l3aloop:
    s_waitcnt vmcnt(24)
    s_barrier
    s_add_u32 s0, s17, s14
    s_and_b32 s0, s0, 3
    s_andn2_b32 s36, s17, 3
    s_or_b32 s0, s0, s36
    s_lshl_b32 s32, s0, 17
    s_add_u32 s32, s32, s10
    s_lshl_b32 s33, s0, 14
    s_add_u32 s33, s33, s11
    s_add_u32 m0, s38, s85
    s_add_u32 s1, s38, 16384
    buffer_load_dwordx4 v148, s[64:67], s32 offen offset:0 lds
    buffer_load_dwordx4 v149, s[64:67], s32 offen offset:1024 lds
    buffer_load_dwordx4 v150, s[64:67], s32 offen offset:2048 lds
    buffer_load_dwordx4 v151, s[64:67], s32 offen offset:3072 lds
    s_add_u32 m0, s1, s85
    s_add_u32 s38, s38, 32768
    buffer_load_dwordx4 v156, s[40:43], s33 offen offset:0 sc1 lds
    buffer_load_dwordx4 v156, s[40:43], s33 offen offset:1024 sc1 lds
    buffer_load_dwordx4 v156, s[40:43], s33 offen offset:2048 sc1 lds
    buffer_load_dwordx4 v156, s[40:43], s33 offen offset:3072 sc1 lds
    s_cmp_eq_u32 s38, 163840
    s_cselect_b32 s38, 0, s38
    s_add_u32 s17, s17, 1
    s_cmp_lt_u32 s17, 8
    s_cbranch_scc1 L_l3aloop
    s_waitcnt vmcnt(24)
    s_barrier
    s_add_u32 s19, s17, 0
    s_add_u32 s0, s19, s14
    s_and_b32 s0, s0, 3
    s_andn2_b32 s36, s19, 3
    s_or_b32 s0, s0, s36
    s_sub_u32 s0, s0, 8
    s_mov_b32 s20, s38
    s_lshl_b32 s33, s0, 18
    s_add_u32 s33, s33, s13
    s_add_u32 s1, s38, 16384
    s_add_u32 m0, s1, s85
    s_add_u32 s38, s38, 32768
    buffer_load_dwordx4 v152, s[68:71], s33 offen offset:0 lds
    buffer_load_dwordx4 v153, s[68:71], s33 offen offset:1024 lds
    buffer_load_dwordx4 v154, s[68:71], s33 offen offset:2048 lds
    buffer_load_dwordx4 v155, s[68:71], s33 offen offset:3072 lds
    s_cmp_eq_u32 s38, 163840
    s_cselect_b32 s38, 0, s38
    buffer_load_dword v120, v122, s[40:43], s15 offen sc0 sc1
    s_waitcnt vmcnt(21)
    s_barrier
    s_add_u32 s19, s17, 1
    s_add_u32 s0, s19, s14
    s_and_b32 s0, s0, 3
    s_andn2_b32 s36, s19, 3
    s_or_b32 s0, s0, s36
    s_sub_u32 s0, s0, 8
    s_mov_b32 s21, s38
    s_lshl_b32 s33, s0, 18
    s_add_u32 s33, s33, s13
    s_add_u32 s1, s38, 16384
    s_add_u32 m0, s1, s85
    s_add_u32 s38, s38, 32768
    buffer_load_dwordx4 v152, s[68:71], s33 offen offset:0 lds
    buffer_load_dwordx4 v153, s[68:71], s33 offen offset:1024 lds
    buffer_load_dwordx4 v154, s[68:71], s33 offen offset:2048 lds
    buffer_load_dwordx4 v155, s[68:71], s33 offen offset:3072 lds
    s_cmp_eq_u32 s38, 163840
    s_cselect_b32 s38, 0, s38
    s_waitcnt vmcnt(17)
    s_barrier
    s_waitcnt vmcnt(4)
    v_cmp_ne_u32 vcc, 1, v120
    s_cbranch_vccnz L_l3slow
    s_add_u32 s19, s17, 0
    s_add_u32 s0, s19, s14
    s_and_b32 s0, s0, 3
    s_andn2_b32 s36, s19, 3
    s_or_b32 s0, s0, s36
    s_sub_u32 s0, s0, 8
    s_lshl_b32 s32, s0, 14
    s_add_u32 m0, s20, s85
    s_add_u32 s32, s32, s12
    buffer_load_dwordx4 v156, s[40:43], s32 offen offset:0 sc1 lds
    buffer_load_dwordx4 v156, s[40:43], s32 offen offset:1024 sc1 lds
    buffer_load_dwordx4 v156, s[40:43], s32 offen offset:2048 sc1 lds
    buffer_load_dwordx4 v156, s[40:43], s32 offen offset:3072 sc1 lds
    s_add_u32 s19, s17, 1
    s_add_u32 s0, s19, s14
    s_and_b32 s0, s0, 3
    s_andn2_b32 s36, s19, 3
    s_or_b32 s0, s0, s36
    s_sub_u32 s0, s0, 8
    s_lshl_b32 s32, s0, 14
    s_add_u32 m0, s21, s85
    s_add_u32 s32, s32, s12
    buffer_load_dwordx4 v156, s[40:43], s32 offen offset:0 sc1 lds
    buffer_load_dwordx4 v156, s[40:43], s32 offen offset:1024 sc1 lds
    buffer_load_dwordx4 v156, s[40:43], s32 offen offset:2048 sc1 lds
    buffer_load_dwordx4 v156, s[40:43], s32 offen offset:3072 sc1 lds
    s_barrier
    s_branch L_l3y2
L_l3slow:
    s_barrier
    s_mov_b32 s101, 0
L_pu_p:
    buffer_load_dword v120, v122, s[40:43], s15 offen sc0 sc1
    s_add_u32 s101, s101, 1
    s_waitcnt vmcnt(0)
    v_cmp_ne_u32 vcc, 1, v120
    s_cbranch_vccz L_pu_ok
    s_sleep 1
    s_cmp_lt_u32 s101, 32768
    s_cbranch_scc1 L_pu_p
L_pu_ok:
    s_add_u32 s19, s17, 0
    s_add_u32 s0, s19, s14
    s_and_b32 s0, s0, 3
    s_andn2_b32 s36, s19, 3
    s_or_b32 s0, s0, s36
    s_sub_u32 s0, s0, 8
    s_lshl_b32 s32, s0, 14
    s_add_u32 m0, s20, s85
    s_add_u32 s32, s32, s12
    buffer_load_dwordx4 v156, s[40:43], s32 offen offset:0 sc1 lds
    buffer_load_dwordx4 v156, s[40:43], s32 offen offset:1024 sc1 lds
    buffer_load_dwordx4 v156, s[40:43], s32 offen offset:2048 sc1 lds
    buffer_load_dwordx4 v156, s[40:43], s32 offen offset:3072 sc1 lds
    s_add_u32 s19, s17, 1
    s_add_u32 s0, s19, s14
    s_and_b32 s0, s0, 3
    s_andn2_b32 s36, s19, 3
    s_or_b32 s0, s0, s36
    s_sub_u32 s0, s0, 8
    s_lshl_b32 s32, s0, 14
    s_add_u32 m0, s21, s85
    s_add_u32 s32, s32, s12
    buffer_load_dwordx4 v156, s[40:43], s32 offen offset:0 sc1 lds
    buffer_load_dwordx4 v156, s[40:43], s32 offen offset:1024 sc1 lds
    buffer_load_dwordx4 v156, s[40:43], s32 offen offset:2048 sc1 lds
    buffer_load_dwordx4 v156, s[40:43], s32 offen offset:3072 sc1 lds
L_l3y2:
    s_mov_b32 s17, 10
L_l3y1:
    s_add_u32 s0, s17, s14
    s_and_b32 s0, s0, 3
    s_andn2_b32 s36, s17, 3
    s_or_b32 s0, s0, s36
    s_sub_u32 s0, s0, 8
    s_lshl_b32 s32, s0, 14
    s_add_u32 s32, s32, s12
    s_lshl_b32 s33, s0, 18
    s_add_u32 s33, s33, s13
    s_add_u32 m0, s38, s85
    s_add_u32 s1, s38, 16384
    buffer_load_dwordx4 v156, s[40:43], s32 offen offset:0 sc1 lds
    buffer_load_dwordx4 v156, s[40:43], s32 offen offset:1024 sc1 lds
    buffer_load_dwordx4 v156, s[40:43], s32 offen offset:2048 sc1 lds
    buffer_load_dwordx4 v156, s[40:43], s32 offen offset:3072 sc1 lds
    s_add_u32 m0, s1, s85
    s_add_u32 s38, s38, 32768
    buffer_load_dwordx4 v152, s[68:71], s33 offen offset:0 lds
    buffer_load_dwordx4 v153, s[68:71], s33 offen offset:1024 lds
    buffer_load_dwordx4 v154, s[68:71], s33 offen offset:2048 lds
    buffer_load_dwordx4 v155, s[68:71], s33 offen offset:3072 lds
    s_cmp_eq_u32 s38, 163840
    s_cselect_b32 s38, 0, s38
    s_add_u32 s17, s17, 1
    s_cmp_lt_u32 s17, 12
    s_cbranch_scc1 L_l3y1
    s_waitcnt vmcnt(20)
    s_branch L_l3yb
L_l3loop:
    s_waitcnt vmcnt(24)
L_l3yb:
    s_barrier
    s_add_u32 s0, s17, s14
    s_and_b32 s0, s0, 3
    s_andn2_b32 s36, s17, 3
    s_or_b32 s0, s0, s36
    s_sub_u32 s0, s0, 8
    s_lshl_b32 s32, s0, 14
    s_add_u32 s32, s32, s12
    s_lshl_b32 s33, s0, 18
    s_add_u32 s33, s33, s13
    s_add_u32 m0, s38, s85
    s_add_u32 s1, s38, 16384
    buffer_load_dwordx4 v156, s[40:43], s32 offen offset:0 sc1 lds
    buffer_load_dwordx4 v156, s[40:43], s32 offen offset:1024 sc1 lds
    buffer_load_dwordx4 v156, s[40:43], s32 offen offset:2048 sc1 lds
    buffer_load_dwordx4 v156, s[40:43], s32 offen offset:3072 sc1 lds
    s_add_u32 m0, s1, s85
    s_add_u32 s38, s38, 32768
    buffer_load_dwordx4 v152, s[68:71], s33 offen offset:0 lds
    buffer_load_dwordx4 v153, s[68:71], s33 offen offset:1024 lds
    buffer_load_dwordx4 v154, s[68:71], s33 offen offset:2048 lds
    buffer_load_dwordx4 v155, s[68:71], s33 offen offset:3072 lds
    s_cmp_eq_u32 s38, 163840
    s_cselect_b32 s38, 0, s38
    s_add_u32 s17, s17, 1
    s_cmp_lt_u32 s17, 36
    s_cbranch_scc1 L_l3loop
    s_waitcnt vmcnt(24)
    s_barrier
    s_waitcnt vmcnt(16)
    s_barrier
    s_waitcnt vmcnt(8)
    s_barrier
    s_waitcnt vmcnt(0)
    s_barrier
L_end:
    s_endpgm
L_consumer:
    s_waitcnt lgkmcnt(0)
    s_mov_b32 s40, s26
    s_mov_b32 s41, s27
    s_mov_b32 s42, 0x1a18000
    s_mov_b32 s43, 0x20000
    s_mov_b32 s44, s4
    s_mov_b32 s45, s5
    s_mov_b32 s46, 0x400000
    s_mov_b32 s47, 0x20000
    s_mov_b32 s52, s20
    s_mov_b32 s53, s21
    s_mov_b32 s54, 0x800
    s_mov_b32 s55, 0x20000
    v_lshlrev_b32 v1, 2, v0
    s_lshl_b32 s36, s2, 3
    s_lshl_b32 s37, s3, 1
    s_add_u32 s35, s36, s37
    s_lshl_b32 s38, s35, 11
    v_lshlrev_b32 v2, 4, v0
    buffer_load_dwordx4 v[16:19], v2, s[44:47], s38 offen offset:0
    buffer_load_dwordx4 v[20:23], v2, s[44:47], s38 offen offset:1024
    buffer_load_dwordx4 v[24:27], v2, s[44:47], s38 offen offset:2048
    buffer_load_dwordx4 v[28:31], v2, s[44:47], s38 offen offset:3072
    buffer_load_dwordx4 v[32:35], v2, s[52:55], 0 offen offset:0
    buffer_load_dwordx4 v[36:39], v2, s[52:55], 0 offen offset:1024
    v_mov_b32 v96, 0
    v_mov_b32 v97, 0
    v_mov_b32 v98, 0
    v_mov_b32 v99, 0
    v_mov_b32 v100, 0
    v_mov_b32 v101, 0
    v_mov_b32 v102, 0
    v_mov_b32 v103, 0
    v_mov_b32 v104, 0
    v_mov_b32 v105, 0
    v_mov_b32 v106, 0
    v_mov_b32 v107, 0
    v_mov_b32 v108, 0
    v_mov_b32 v109, 0
    v_mov_b32 v110, 0
    v_mov_b32 v111, 0
    v_mov_b32 v112, 0
    v_mov_b32 v113, 0
    v_mov_b32 v114, 0
    v_mov_b32 v115, 0
    v_mov_b32 v116, 0
    v_mov_b32 v117, 0
    v_mov_b32 v118, 0
    v_mov_b32 v119, 0
    v_mov_b32 v120, 0
    v_mov_b32 v121, 0
    v_mov_b32 v122, 0
    v_mov_b32 v123, 0
    v_mov_b32 v124, 0
    v_mov_b32 v125, 0
    v_mov_b32 v126, 0
    v_mov_b32 v127, 0
    s_lshl_b32 s36, s3, 12
    s_add_u32 s36, s36, 135168
    v_add_u32 v90, s36, v2
    s_lshl_b32 s36, s3, 9
    s_add_u32 s36, s36, 135168
    v_lshl_add_u32 v91, v0, 1, s36
    s_cmp_lg_u32 s3, 3
    s_cbranch_scc1 L_nz
    s_cmp_ge_u32 s2, 64
    s_cbranch_scc1 L_nz
    v_lshlrev_b32 v3, 4, v0
    v_mov_b32 v4, 0
    v_mov_b32 v5, 0
    v_mov_b32 v6, 0
    v_mov_b32 v7, 0
    s_lshl_b32 s36, s2, 10
    s_add_u32 s36, s36, 27262976
    buffer_store_dwordx4 v[4:7], v3, s[40:43], s36 offen sc0 sc1
L_nz:
    s_cmp_lg_u32 s3, 2
    s_cbranch_scc1 L_nz2
    v_mov_b32 v4, 0
    s_lshl_b32 s36, s2, 7
    s_add_u32 s36, s36, 27328512
    s_mov_b32 exec_hi, 0
    buffer_store_dword v4, v1, s[40:43], s36 offen sc0 sc1
    s_mov_b64 exec, -1
L_nz2:
    v_mov_b32 v80, 0x3f803f80
    v_mov_b32 v76, 0
    v_mov_b32 v77, 0
    v_mov_b32 v78, 0
    v_mov_b32 v79, 0
    s_mov_b32 s48, s6
    s_mov_b32 s49, s7
    s_mov_b32 s50, 0x600000
    s_mov_b32 s51, 0x20000
    s_mov_b32 s56, s12
    s_mov_b32 s57, s13
    s_mov_b32 s58, 0xe00000
    s_mov_b32 s59, 0x20000
    s_mov_b32 s60, s14
    s_mov_b32 s61, s15
    s_mov_b32 s62, 0x1c00
    s_mov_b32 s63, 0x20000
    s_mov_b32 s64, s8
    s_mov_b32 s65, s9
    s_mov_b32 s66, 0x200000
    s_mov_b32 s67, 0x20000
    s_mov_b32 s68, s16
    s_mov_b32 s69, s17
    s_mov_b32 s70, 0xe00000
    s_mov_b32 s71, 0x20000
    s_mov_b32 s72, s18
    s_mov_b32 s73, s19
    s_mov_b32 s74, 0x1000
    s_mov_b32 s75, 0x20000
    s_mov_b32 s76, s22
    s_mov_b32 s77, s23
    s_mov_b32 s78, 0x400000
    s_mov_b32 s79, 0x20000
    s_mov_b32 s80, s24
    s_mov_b32 s81, s25
    s_mov_b32 s82, 0x100
    s_mov_b32 s83, 0x20000
    s_mov_b32 s26, s35
    s_and_b32 s36, s30, 7
    s_lshl_b32 s36, s36, 3
    s_lshr_b32 s37, s31, 3
    s_add_u32 s36, s36, s37
    s_lshr_b32 s37, s30, 3
    s_lshl_b32 s37, s37, 1
    s_add_u32 s36, s36, s37
    s_lshl_b32 s36, s36, 7
    s_and_b32 s37, s31, 7
    s_lshl_b32 s37, s37, 2
    s_add_u32 s36, s36, s37
    s_add_u32 s36, s36, 27328576
    v_and_b32 v241, 3, v0
    v_lshlrev_b32 v241, 13, v241
    v_bfe_u32 v128, v0, 2, 1
    v_lshl_add_u32 v241, v128, 9, v241
    v_add_u32 v241, s36, v241
    v_and_b32 v128, 15, v0
    v_lshrrev_b32 v129, 4, v0
    v_and_b32 v130, 1, v128
    v_lshrrev_b32 v131, 1, v128
    v_mul_u32_u24 v132, 72, v130
    v_add_u32 v131, v131, v132
    v_lshlrev_b32 v131, 7, v131
    v_lshrrev_b32 v132, 2, v128
    v_lshl_add_u32 v132, v130, 2, v132
    v_lshrrev_b32 v133, 1, v129
    s_lshl_b32 s36, s3, 1
    v_add_u32 v133, s36, v133
    v_xor_b32 v133, v133, v132
    v_lshl_add_u32 v131, v133, 4, v131
    v_and_b32 v133, 1, v129
    v_lshl_add_u32 v131, v133, 3, v131
    v_add_u32 v235, 1024, v131
    v_xor_b32 v236, 64, v235
    s_and_b32 s34, s3, 1
    s_lshr_b32 s35, s3, 1
    v_and_b32 v128, 3, v0
    v_bfe_u32 v129, v0, 2, 2
    v_lshrrev_b32 v130, 4, v0
    v_and_b32 v133, 1, v130
    v_lshl_add_u32 v133, v133, 2, v129
    v_lshlrev_b32 v133, 1, v133
    v_lshrrev_b32 v132, 1, v128
    v_and_b32 v134, 1, v128
    v_lshlrev_b32 v134, 3, v134
    v_lshl_add_u32 v131, v130, 3, v129
    v_lshl_add_u32 v131, v131, 8, v134
    s_lshl_b32 s36, s34, 3
    s_add_u32 s37, s36, 0
    v_add_u32 v135, s37, v132
    v_xor_b32 v135, v135, v133
    v_lshl_add_u32 v220, v135, 4, v131
    s_add_u32 s37, s36, 2
    v_add_u32 v135, s37, v132
    v_xor_b32 v135, v135, v133
    v_lshl_add_u32 v221, v135, 4, v131
    s_add_u32 s37, s36, 4
    v_add_u32 v135, s37, v132
    v_xor_b32 v135, v135, v133
    v_lshl_add_u32 v222, v135, 4, v131
    s_add_u32 s37, s36, 6
    v_add_u32 v135, s37, v132
    v_xor_b32 v135, v135, v133
    v_lshl_add_u32 v223, v135, 4, v131
    s_lshl_b32 s36, s35, 12
    s_add_u32 s36, s36, 16384
    v_lshlrev_b32 v224, 4, v0
    v_add_u32 v224, s36, v224
    v_lshl_add_u32 v131, v130, 2, v129
    v_lshl_add_u32 v131, v131, 8, v134
    s_lshl_b32 s36, s34, 3
    s_add_u32 s37, s36, 0
    v_add_u32 v135, s37, v132
    v_xor_b32 v135, v135, v133
    v_lshl_add_u32 v225, v135, 4, v131
    s_add_u32 s37, s36, 2
    v_add_u32 v135, s37, v132
    v_xor_b32 v135, v135, v133
    v_lshl_add_u32 v226, v135, 4, v131
    s_add_u32 s37, s36, 4
    v_add_u32 v135, s37, v132
    v_xor_b32 v135, v135, v133
    v_lshl_add_u32 v227, v135, 4, v131
    s_add_u32 s37, s36, 6
    v_add_u32 v135, s37, v132
    v_xor_b32 v135, v135, v133
    v_lshl_add_u32 v228, v135, 4, v131
    s_lshl_b32 s36, s35, 12
    s_add_u32 s36, s36, 16384
    v_lshlrev_b32 v229, 4, v0
    v_add_u32 v229, s36, v229
    v_lshl_add_u32 v131, v130, 2, v129
    v_lshl_add_u32 v131, v131, 8, v134
    v_add_u32 v131, 16384, v131
    s_lshl_b32 s36, s35, 3
    s_add_u32 s37, s36, 0
    v_add_u32 v135, s37, v132
    v_xor_b32 v135, v135, v133
    v_lshl_add_u32 v230, v135, 4, v131
    s_add_u32 s37, s36, 2
    v_add_u32 v135, s37, v132
    v_xor_b32 v135, v135, v133
    v_lshl_add_u32 v231, v135, 4, v131
    s_add_u32 s37, s36, 4
    v_add_u32 v135, s37, v132
    v_xor_b32 v135, v135, v133
    v_lshl_add_u32 v232, v135, 4, v131
    s_add_u32 s37, s36, 6
    v_add_u32 v135, s37, v132
    v_xor_b32 v135, v135, v133
    v_lshl_add_u32 v233, v135, 4, v131
    s_lshl_b32 s36, s34, 12
    v_lshlrev_b32 v234, 4, v0
    v_add_u32 v234, s36, v234
    s_and_b32 s34, s3, 1
    s_lshr_b32 s38, s3, 1
    s_lshl_b32 s36, s38, 4
    s_sub_u32 s36, s36, 8
    s_lshl_b32 s36, s36, 7
    s_add_u32 s39, s36, 1024
    s_lshl_b32 s36, s34, 2
    v_and_b32 v128, 15, v0
    v_lshrrev_b32 v129, 4, v0
    v_lshrrev_b32 v130, 1, v128
    v_add_u32 v130, 4, v130
    v_and_b32 v130, 7, v130
    v_add_u32 v131, s36, v129
    v_xor_b32 v131, v131, v130
    v_lshlrev_b32 v131, 4, v131
    v_lshl_add_u32 v131, v128, 7, v131
    v_add_u32 v237, s39, v131
    v_and_b32 v132, 3, v0
    v_bfe_u32 v133, v0, 2, 2
    v_lshrrev_b32 v130, 1, v133
    v_lshl_add_u32 v130, v129, 1, v130
    v_add_u32 v130, 4, v130
    v_and_b32 v130, 7, v130
    v_lshrrev_b32 v131, 1, v132
    v_add_u32 v131, s36, v131
    v_xor_b32 v131, v131, v130
    v_lshlrev_b32 v131, 4, v131
    v_and_b32 v134, 1, v132
    v_lshl_add_u32 v131, v134, 3, v131
    v_lshl_add_u32 v134, v129, 2, v133
    v_lshl_add_u32 v131, v134, 7, v131
    v_add_u32 v238, s39, v131
    v_lshlrev_b32 v134, 2, v129
    v_sub_u32 v134, v128, v134
    v_subrev_u32 v135, 0, v134
    v_cmp_gt_u32 s[4:5], 8, v135
    v_add_u32 v135, 16, v134
    v_cmp_gt_u32 s[12:13], 8, v135
    v_subrev_u32 v135, 1, v134
    v_cmp_gt_u32 s[6:7], 8, v135
    v_add_u32 v135, 15, v134
    v_cmp_gt_u32 s[14:15], 8, v135
    v_subrev_u32 v135, 2, v134
    v_cmp_gt_u32 s[8:9], 8, v135
    v_add_u32 v135, 14, v134
    v_cmp_gt_u32 s[16:17], 8, v135
    v_subrev_u32 v135, 3, v134
    v_cmp_gt_u32 s[10:11], 8, v135
    v_add_u32 v135, 13, v134
    v_cmp_gt_u32 s[18:19], 8, v135
    s_lshl_b32 s37, s3, 11
    s_add_u32 s37, s37, 1024
    v_lshrrev_b32 v130, 3, v128
    v_lshlrev_b32 v130, 10, v130
    v_lshl_add_u32 v130, v129, 8, v130
    v_and_b32 v131, 7, v128
    v_lshl_add_u32 v130, v131, 5, v130
    v_add_u32 v239, s37, v130
    v_lshlrev_b32 v130, 4, v0
    v_add_u32 v240, s37, v130
    s_or_b32 s36, s30, s38
    s_cmp_eq_u32 s36, 0
    s_cselect_b64 s[12:13], 0, s[12:13]
    s_cselect_b64 s[14:15], 0, s[14:15]
    s_cselect_b64 s[16:17], 0, s[16:17]
    s_cselect_b64 s[18:19], 0, s[18:19]
    s_lshl_b32 s36, s30, 18
    s_lshl_b32 s37, s31, 1
    s_add_u32 s37, s37, s34
    s_lshl_b32 s37, s37, 13
    s_add_u32 s36, s36, s37
    s_lshl_b32 s37, s38, 11
    s_add_u32 s36, s36, s37
    s_add_u32 s84, s36, 12582912
    s_and_b32 s34, s3, 1
    s_lshr_b32 s35, s3, 1
    s_and_b32 s30, s28, 1
    s_lshl_b32 s30, s30, 2
    s_and_b32 s32, s29, 3
    s_add_u32 s30, s30, s32
    s_lshr_b32 s31, s28, 1
    s_mul_i32 s31, s31, 7
    s_lshr_b32 s33, s29, 2
    s_add_u32 s31, s31, s33
    s_cmp_ge_u32 s31, 14
    s_cselect_b32 s37, 1, 0
    s_cselect_b32 s38, 14, 0
    s_sub_u32 s38, s31, s38
    s_and_b32 s36, s30, 3
    s_lshl_b32 s36, s36, 6
    s_add_u32 s36, s36, s37
    s_lshr_b32 s37, s30, 2
    s_lshl_b32 s37, s37, 2
    s_add_u32 s36, s36, s37
    s_lshl_b32 s36, s36, 7
    s_lshl_b32 s38, s38, 2
    s_add_u32 s36, s36, s38
    s_add_u32 s36, s36, 27328512
    v_and_b32 v242, 7, v0
    v_lshlrev_b32 v242, 10, v242
    v_bfe_u32 v128, v0, 3, 1
    v_lshl_add_u32 v242, v128, 8, v242
    v_add_u32 v242, s36, v242
    s_lshl_b32 s36, s31, 8
    s_lshl_b32 s37, s34, 7
    s_add_u32 s38, s36, s37
    v_lshrrev_b32 v15, 4, v0
    v_lshlrev_b32 v15, 3, v15
    s_mov_b32 s27, s38
    s_bfe_u32 s36, s28, 0x10001
    s_lshl_b32 s36, s36, 3
    s_and_b32 s37, s29, 7
    s_add_u32 s36, s36, s37
    s_lshl_b32 s36, s36, 7
    s_lshl_b32 s37, s35, 6
    s_add_u32 s85, s36, s37
    v_and_b32 v8, 15, v0
    v_add_u32 v8, s85, v8
    v_lshlrev_b32 v8, 1, v8
    v_and_b32 v128, 3, v0
    v_bfe_u32 v129, v0, 2, 2
    v_lshrrev_b32 v130, 4, v0
    v_lshl_add_u32 v131, v130, 3, v129
    v_lshlrev_b32 v131, 7, v131
    v_and_b32 v132, 1, v128
    v_lshl_add_u32 v131, v132, 3, v131
    v_lshrrev_b32 v132, 1, v129
    v_and_b32 v133, 1, v130
    v_lshl_add_u32 v132, v133, 1, v132
    v_lshlrev_b32 v132, 1, v132
    v_lshrrev_b32 v133, 1, v128
    s_lshl_b32 s36, s3, 1
    v_add_u32 v133, s36, v133
    v_xor_b32 v133, v133, v132
    v_lshl_add_u32 v12, v133, 4, v131
    v_add_u32 v12, 18432, v12
    v_and_b32 v131, 15, v0
    v_lshrrev_b32 v132, 1, v131
    v_xor_b32 v132, v132, v130
    v_lshlrev_b32 v132, 4, v132
    v_lshl_add_u32 v13, v131, 7, v132
    v_xor_b32 v14, 64, v13
    v_mov_b32 v9, v12
    v_mov_b32 v10, v13
    v_mov_b32 v11, v14
    v_mov_b32 v128, 0
    v_mov_b32 v129, 0
    v_mov_b32 v130, 0
    v_mov_b32 v131, 0
    v_mov_b32 v132, 0
    v_mov_b32 v133, 0
    v_mov_b32 v134, 0
    v_mov_b32 v135, 0
    v_mov_b32 v136, 0
    v_mov_b32 v137, 0
    v_mov_b32 v138, 0
    v_mov_b32 v139, 0
    v_mov_b32 v140, 0
    v_mov_b32 v141, 0
    v_mov_b32 v142, 0
    v_mov_b32 v143, 0
    v_mov_b32 v144, 0
    v_mov_b32 v145, 0
    v_mov_b32 v146, 0
    v_mov_b32 v147, 0
    v_mov_b32 v148, 0
    v_mov_b32 v149, 0
    v_mov_b32 v150, 0
    v_mov_b32 v151, 0
    v_mov_b32 v152, 0
    v_mov_b32 v153, 0
    v_mov_b32 v154, 0
    v_mov_b32 v155, 0
    v_mov_b32 v156, 0
    v_mov_b32 v157, 0
    v_mov_b32 v158, 0
    v_mov_b32 v159, 0
    v_mov_b32 v160, 0
    v_mov_b32 v161, 0
    v_mov_b32 v162, 0
    v_mov_b32 v163, 0
    v_mov_b32 v164, 0
    v_mov_b32 v165, 0
    v_mov_b32 v166, 0
    v_mov_b32 v167, 0
    v_mov_b32 v168, 0
    v_mov_b32 v169, 0
    v_mov_b32 v170, 0
    v_mov_b32 v171, 0
    v_mov_b32 v172, 0
    v_mov_b32 v173, 0
    v_mov_b32 v174, 0
    v_mov_b32 v175, 0
    v_mov_b32 v176, 0
    v_mov_b32 v177, 0
    v_mov_b32 v178, 0
    v_mov_b32 v179, 0
    v_mov_b32 v180, 0
    v_mov_b32 v181, 0
    v_mov_b32 v182, 0
    v_mov_b32 v183, 0
    v_mov_b32 v184, 0
    v_mov_b32 v185, 0
    v_mov_b32 v186, 0
    v_mov_b32 v187, 0
    v_mov_b32 v188, 0
    v_mov_b32 v189, 0
    v_mov_b32 v190, 0
    v_mov_b32 v191, 0
    v_mov_b32 v192, 0
    v_mov_b32 v193, 0
    v_mov_b32 v194, 0
    v_mov_b32 v195, 0
    v_mov_b32 v196, 0
    v_mov_b32 v197, 0
    v_mov_b32 v198, 0
    v_mov_b32 v199, 0
    v_mov_b32 v200, 0
    v_mov_b32 v201, 0
    v_mov_b32 v202, 0
    v_mov_b32 v203, 0
    v_mov_b32 v204, 0
    v_mov_b32 v205, 0
    v_mov_b32 v206, 0
    v_mov_b32 v207, 0
    v_mov_b32 v208, 0
    v_mov_b32 v209, 0
    v_mov_b32 v210, 0
    v_mov_b32 v211, 0
    v_mov_b32 v212, 0
    v_mov_b32 v213, 0
    v_mov_b32 v214, 0
    v_mov_b32 v215, 0
    v_mov_b32 v216, 0
    v_mov_b32 v217, 0
    v_mov_b32 v218, 0
    v_mov_b32 v219, 0
    buffer_load_dwordx2 v[244:245], v15, s[60:63], s27 offen offset:0
    buffer_load_dwordx2 v[246:247], v15, s[60:63], s27 offen offset:32
    buffer_load_dwordx2 v[248:249], v15, s[60:63], s27 offen offset:64
    buffer_load_dwordx2 v[250:251], v15, s[60:63], s27 offen offset:96
    buffer_load_ushort v252, v8, s[72:75], 0 offen offset:0
    buffer_load_ushort v253, v8, s[72:75], 0 offen offset:32
    buffer_load_ushort v254, v8, s[72:75], 0 offen offset:64
    buffer_load_ushort v255, v8, s[72:75], 0 offen offset:96
    s_mov_b32 s35, s26
    s_waitcnt vmcnt(8)
    ds_write_b128 v90, v[16:19] offset:0
    ds_write_b128 v90, v[20:23] offset:1024
    ds_write_b128 v90, v[24:27] offset:2048
    ds_write_b128 v90, v[28:31] offset:3072
    v_dot2_f32_bf16 v76, v16, v80, v76
    v_dot2_f32_bf16 v78, v16, v32, v78
    v_lshlrev_b32 v40, 16, v16
    v_and_b32 v41, 0xffff0000, v16
    v_dot2_f32_bf16 v77, v24, v80, v77
    v_dot2_f32_bf16 v79, v24, v32, v79
    v_lshlrev_b32 v56, 16, v24
    v_and_b32 v57, 0xffff0000, v24
    v_dot2_f32_bf16 v76, v17, v80, v76
    v_dot2_f32_bf16 v78, v17, v33, v78
    v_lshlrev_b32 v42, 16, v17
    v_and_b32 v43, 0xffff0000, v17
    v_dot2_f32_bf16 v77, v25, v80, v77
    v_dot2_f32_bf16 v79, v25, v33, v79
    v_lshlrev_b32 v58, 16, v25
    v_and_b32 v59, 0xffff0000, v25
    v_dot2_f32_bf16 v76, v18, v80, v76
    v_dot2_f32_bf16 v78, v18, v34, v78
    v_lshlrev_b32 v44, 16, v18
    v_and_b32 v45, 0xffff0000, v18
    v_dot2_f32_bf16 v77, v26, v80, v77
    v_dot2_f32_bf16 v79, v26, v34, v79
    v_lshlrev_b32 v60, 16, v26
    v_and_b32 v61, 0xffff0000, v26
    v_dot2_f32_bf16 v76, v19, v80, v76
    v_dot2_f32_bf16 v78, v19, v35, v78
    v_lshlrev_b32 v46, 16, v19
    v_and_b32 v47, 0xffff0000, v19
    v_dot2_f32_bf16 v77, v27, v80, v77
    v_dot2_f32_bf16 v79, v27, v35, v79
    v_lshlrev_b32 v62, 16, v27
    v_and_b32 v63, 0xffff0000, v27
    v_dot2_f32_bf16 v76, v20, v80, v76
    v_dot2_f32_bf16 v78, v20, v36, v78
    v_lshlrev_b32 v48, 16, v20
    v_and_b32 v49, 0xffff0000, v20
    v_dot2_f32_bf16 v77, v28, v80, v77
    v_dot2_f32_bf16 v79, v28, v36, v79
    v_lshlrev_b32 v64, 16, v28
    v_and_b32 v65, 0xffff0000, v28
    v_dot2_f32_bf16 v76, v21, v80, v76
    v_dot2_f32_bf16 v78, v21, v37, v78
    v_lshlrev_b32 v50, 16, v21
    v_and_b32 v51, 0xffff0000, v21
    v_dot2_f32_bf16 v77, v29, v80, v77
    v_dot2_f32_bf16 v79, v29, v37, v79
    v_lshlrev_b32 v66, 16, v29
    v_and_b32 v67, 0xffff0000, v29
    v_dot2_f32_bf16 v76, v22, v80, v76
    v_dot2_f32_bf16 v78, v22, v38, v78
    v_lshlrev_b32 v52, 16, v22
    v_and_b32 v53, 0xffff0000, v22
    v_dot2_f32_bf16 v77, v30, v80, v77
    v_dot2_f32_bf16 v79, v30, v38, v79
    v_lshlrev_b32 v68, 16, v30
    v_and_b32 v69, 0xffff0000, v30
    v_dot2_f32_bf16 v76, v23, v80, v76
    v_dot2_f32_bf16 v78, v23, v39, v78
    v_lshlrev_b32 v54, 16, v23
    v_and_b32 v55, 0xffff0000, v23
    v_dot2_f32_bf16 v77, v31, v80, v77
    v_dot2_f32_bf16 v79, v31, v39, v79
    v_lshlrev_b32 v70, 16, v31
    v_and_b32 v71, 0xffff0000, v31
    s_nop 2
    v_add_f32_dpp v76, v76, v76 row_shr:1 row_mask:0xf bank_mask:0xf
    v_add_f32_dpp v77, v77, v77 row_shr:1 row_mask:0xf bank_mask:0xf
    v_add_f32_dpp v78, v78, v78 row_shr:1 row_mask:0xf bank_mask:0xf
    v_add_f32_dpp v79, v79, v79 row_shr:1 row_mask:0xf bank_mask:0xf
    v_add_f32_dpp v76, v76, v76 row_shr:2 row_mask:0xf bank_mask:0xf
    v_add_f32_dpp v77, v77, v77 row_shr:2 row_mask:0xf bank_mask:0xf
    v_add_f32_dpp v78, v78, v78 row_shr:2 row_mask:0xf bank_mask:0xf
    v_add_f32_dpp v79, v79, v79 row_shr:2 row_mask:0xf bank_mask:0xf
    v_add_f32_dpp v76, v76, v76 row_shr:4 row_mask:0xf bank_mask:0xf
    v_add_f32_dpp v77, v77, v77 row_shr:4 row_mask:0xf bank_mask:0xf
    v_add_f32_dpp v78, v78, v78 row_shr:4 row_mask:0xf bank_mask:0xf
    v_add_f32_dpp v79, v79, v79 row_shr:4 row_mask:0xf bank_mask:0xf
    v_add_f32_dpp v76, v76, v76 row_shr:8 row_mask:0xf bank_mask:0xf
    v_add_f32_dpp v77, v77, v77 row_shr:8 row_mask:0xf bank_mask:0xf
    v_add_f32_dpp v78, v78, v78 row_shr:8 row_mask:0xf bank_mask:0xf
    v_add_f32_dpp v79, v79, v79 row_shr:8 row_mask:0xf bank_mask:0xf
    v_add_f32_dpp v76, v76, v76 row_bcast:15 row_mask:0xa bank_mask:0xf
    v_add_f32_dpp v77, v77, v77 row_bcast:15 row_mask:0xa bank_mask:0xf
    v_add_f32_dpp v78, v78, v78 row_bcast:15 row_mask:0xa bank_mask:0xf
    v_add_f32_dpp v79, v79, v79 row_bcast:15 row_mask:0xa bank_mask:0xf
    v_add_f32_dpp v76, v76, v76 row_bcast:31 row_mask:0xc bank_mask:0xf
    v_add_f32_dpp v77, v77, v77 row_bcast:31 row_mask:0xc bank_mask:0xf
    v_add_f32_dpp v78, v78, v78 row_bcast:31 row_mask:0xc bank_mask:0xf
    v_add_f32_dpp v79, v79, v79 row_bcast:31 row_mask:0xc bank_mask:0xf
    s_nop 1
    v_readlane_b32 s20, v76, 63
    v_readlane_b32 s21, v77, 63
    v_readlane_b32 s22, v78, 63
    v_readlane_b32 s23, v79, 63
    s_nop 1
    v_mov_b32 v81, 0x3a800000
    v_mul_f32 v82, s20, v81
    v_mul_f32 v83, s21, v81
    v_mov_b32 v76, 0
    v_mov_b32 v77, 0
    v_sub_f32 v40, v40, v82
    v_fmac_f32 v76, v40, v40
    v_sub_f32 v56, v56, v83
    v_fmac_f32 v77, v56, v56
    v_sub_f32 v41, v41, v82
    v_fmac_f32 v76, v41, v41
    v_sub_f32 v57, v57, v83
    v_fmac_f32 v77, v57, v57
    v_sub_f32 v42, v42, v82
    v_fmac_f32 v76, v42, v42
    v_sub_f32 v58, v58, v83
    v_fmac_f32 v77, v58, v58
    v_sub_f32 v43, v43, v82
    v_fmac_f32 v76, v43, v43
    v_sub_f32 v59, v59, v83
    v_fmac_f32 v77, v59, v59
    v_sub_f32 v44, v44, v82
    v_fmac_f32 v76, v44, v44
    v_sub_f32 v60, v60, v83
    v_fmac_f32 v77, v60, v60
    v_sub_f32 v45, v45, v82
    v_fmac_f32 v76, v45, v45
    v_sub_f32 v61, v61, v83
    v_fmac_f32 v77, v61, v61
    v_sub_f32 v46, v46, v82
    v_fmac_f32 v76, v46, v46
    v_sub_f32 v62, v62, v83
    v_fmac_f32 v77, v62, v62
    v_sub_f32 v47, v47, v82
    v_fmac_f32 v76, v47, v47
    v_sub_f32 v63, v63, v83
    v_fmac_f32 v77, v63, v63
    v_sub_f32 v48, v48, v82
    v_fmac_f32 v76, v48, v48
    v_sub_f32 v64, v64, v83
    v_fmac_f32 v77, v64, v64
    v_sub_f32 v49, v49, v82
    v_fmac_f32 v76, v49, v49
    v_sub_f32 v65, v65, v83
    v_fmac_f32 v77, v65, v65
    v_sub_f32 v50, v50, v82
    v_fmac_f32 v76, v50, v50
    v_sub_f32 v66, v66, v83
    v_fmac_f32 v77, v66, v66
    v_sub_f32 v51, v51, v82
    v_fmac_f32 v76, v51, v51
    v_sub_f32 v67, v67, v83
    v_fmac_f32 v77, v67, v67
    v_sub_f32 v52, v52, v82
    v_fmac_f32 v76, v52, v52
    v_sub_f32 v68, v68, v83
    v_fmac_f32 v77, v68, v68
    v_sub_f32 v53, v53, v82
    v_fmac_f32 v76, v53, v53
    v_sub_f32 v69, v69, v83
    v_fmac_f32 v77, v69, v69
    v_sub_f32 v54, v54, v82
    v_fmac_f32 v76, v54, v54
    v_sub_f32 v70, v70, v83
    v_fmac_f32 v77, v70, v70
    v_sub_f32 v55, v55, v82
    v_fmac_f32 v76, v55, v55
    v_sub_f32 v71, v71, v83
    v_fmac_f32 v77, v71, v71
    s_nop 2
    v_add_f32_dpp v76, v76, v76 row_shr:1 row_mask:0xf bank_mask:0xf
    v_add_f32_dpp v77, v77, v77 row_shr:1 row_mask:0xf bank_mask:0xf
    s_nop 1
    v_add_f32_dpp v76, v76, v76 row_shr:2 row_mask:0xf bank_mask:0xf
    v_add_f32_dpp v77, v77, v77 row_shr:2 row_mask:0xf bank_mask:0xf
    s_nop 1
    v_add_f32_dpp v76, v76, v76 row_shr:4 row_mask:0xf bank_mask:0xf
    v_add_f32_dpp v77, v77, v77 row_shr:4 row_mask:0xf bank_mask:0xf
    s_nop 1
    v_add_f32_dpp v76, v76, v76 row_shr:8 row_mask:0xf bank_mask:0xf
    v_add_f32_dpp v77, v77, v77 row_shr:8 row_mask:0xf bank_mask:0xf
    s_nop 1
    v_add_f32_dpp v76, v76, v76 row_bcast:15 row_mask:0xa bank_mask:0xf
    v_add_f32_dpp v77, v77, v77 row_bcast:15 row_mask:0xa bank_mask:0xf
    s_nop 1
    v_add_f32_dpp v76, v76, v76 row_bcast:31 row_mask:0xc bank_mask:0xf
    v_add_f32_dpp v77, v77, v77 row_bcast:31 row_mask:0xc bank_mask:0xf
    s_nop 1
    s_nop 1
    v_readlane_b32 s24, v76, 63
    v_readlane_b32 s25, v77, 63
    v_cmp_eq_u32 vcc, 1, v0
    v_mov_b32 v84, 0x3727c5ac
    v_mov_b32 v86, s24
    v_mov_b32 v87, s25
    v_cndmask_b32 v86, v86, v87, vcc
    v_cndmask_b32 v82, v82, v83, vcc
    v_fma_f32 v86, v86, v81, v84
    v_rsq_f32 v88, v86
    v_mov_b32 v85, s22
    v_mov_b32 v87, s23
    v_cndmask_b32 v85, v85, v87, vcc
    v_mul_f32 v89, v82, v88
    v_sub_f32 v89, 0, v89
    v_mul_f32 v85, 0xbfb8aa3b, v85
    v_exp_f32 v85, v85
    s_lshl_b32 s36, s3, 4
    v_add_f32 v85, 1.0, v85
    v_rcp_f32 v85, v85
    v_lshl_add_u32 v3, v0, 3, s36
    v_add_u32 v3, 163328, v3
    s_lshl_b32 s36, s35, 2
    s_add_u32 s36, s36, 16777216
    s_mov_b64 exec, 3
    ds_write_b64 v3, v[88:89]
    buffer_store_dword v85, v1, s[40:43], s36 offen sc0 sc1
    s_mov_b64 exec, -1
    v_mov_b32 v3, 163328
    s_waitcnt lgkmcnt(0)
    s_barrier
    ds_read_b128 v[16:19], v3 offset:0
    ds_read_b128 v[20:23], v3 offset:16
    ds_read_b128 v[24:27], v3 offset:32
    ds_read_b128 v[28:31], v3 offset:48
    ds_read_u16_d16_hi v96, v91 offset:0
    ds_read_u16_d16_hi v97, v91 offset:2048
    ds_read_u16_d16_hi v98, v91 offset:4096
    ds_read_u16_d16_hi v99, v91 offset:6144
    ds_read_u16_d16_hi v100, v91 offset:8192
    ds_read_u16_d16_hi v101, v91 offset:10240
    ds_read_u16_d16_hi v102, v91 offset:12288
    ds_read_u16_d16_hi v103, v91 offset:14336
    ds_read_u16_d16_hi v104, v91 offset:128
    ds_read_u16_d16_hi v105, v91 offset:2176
    s_waitcnt lgkmcnt(4)
    ds_read_u16_d16_hi v106, v91 offset:4224
    ds_read_u16_d16_hi v107, v91 offset:6272
    ds_read_u16_d16_hi v108, v91 offset:8320
    ds_read_u16_d16_hi v109, v91 offset:10368
    ds_read_u16_d16_hi v110, v91 offset:12416
    ds_read_u16_d16_hi v111, v91 offset:14464
    ds_read_u16_d16_hi v112, v91 offset:256
    ds_read_u16_d16_hi v113, v91 offset:2304
    ds_read_u16_d16_hi v114, v91 offset:4352
    ds_read_u16_d16_hi v115, v91 offset:6400
    s_waitcnt lgkmcnt(4)
    ds_read_u16_d16_hi v116, v91 offset:8448
    ds_read_u16_d16_hi v117, v91 offset:10496
    ds_read_u16_d16_hi v118, v91 offset:12544
    ds_read_u16_d16_hi v119, v91 offset:14592
    ds_read_u16_d16_hi v120, v91 offset:384
    ds_read_u16_d16_hi v121, v91 offset:2432
    ds_read_u16_d16_hi v122, v91 offset:4480
    ds_read_u16_d16_hi v123, v91 offset:6528
    ds_read_u16_d16_hi v124, v91 offset:8576
    ds_read_u16_d16_hi v125, v91 offset:10624
    s_waitcnt lgkmcnt(4)
    ds_read_u16_d16_hi v126, v91 offset:12672
    ds_read_u16_d16_hi v127, v91 offset:14720
    v_lshrrev_b32 v4, 4, v0
    v_lshlrev_b32 v4, 10, v4
    v_and_b32 v5, 15, v0
    v_lshl_add_u32 v4, v5, 4, v4
    v_add_u32 v5, 4096, v4
    s_lshl_b32 s36, s3, 20
    s_lshr_b32 s37, s2, 2
    s_lshl_b32 s37, s37, 13
    s_add_u32 s36, s36, s37
    s_and_b32 s37, s2, 3
    s_lshl_b32 s37, s37, 8
    s_add_u32 s36, s36, s37
    s_add_u32 s37, s36, 0x80000
    s_waitcnt lgkmcnt(0)
    v_fma_f32 v96, v96, v16, v17
    v_fma_f32 v97, v97, v18, v19
    v_fma_f32 v98, v98, v20, v21
    v_fma_f32 v99, v99, v22, v23
    v_fma_f32 v100, v100, v24, v25
    v_fma_f32 v101, v101, v26, v27
    v_fma_f32 v102, v102, v28, v29
    v_fma_f32 v103, v103, v30, v31
    v_cvt_pk_bf16_f32 v72, v96, v97
    v_cvt_pk_bf16_f32 v73, v98, v99
    v_cvt_pk_bf16_f32 v74, v100, v101
    v_cvt_pk_bf16_f32 v75, v102, v103
    buffer_store_dwordx4 v[72:75], v4, s[40:43], s36 offen sc0 sc1
    v_fma_f32 v104, v104, v16, v17
    v_fma_f32 v105, v105, v18, v19
    v_fma_f32 v106, v106, v20, v21
    v_fma_f32 v107, v107, v22, v23
    v_fma_f32 v108, v108, v24, v25
    v_fma_f32 v109, v109, v26, v27
    v_fma_f32 v110, v110, v28, v29
    v_fma_f32 v111, v111, v30, v31
    v_cvt_pk_bf16_f32 v76, v104, v105
    v_cvt_pk_bf16_f32 v77, v106, v107
    v_cvt_pk_bf16_f32 v78, v108, v109
    v_cvt_pk_bf16_f32 v79, v110, v111
    buffer_store_dwordx4 v[76:79], v5, s[40:43], s36 offen sc0 sc1
    v_fma_f32 v112, v112, v16, v17
    v_fma_f32 v113, v113, v18, v19
    v_fma_f32 v114, v114, v20, v21
    v_fma_f32 v115, v115, v22, v23
    v_fma_f32 v116, v116, v24, v25
    v_fma_f32 v117, v117, v26, v27
    v_fma_f32 v118, v118, v28, v29
    v_fma_f32 v119, v119, v30, v31
    v_cvt_pk_bf16_f32 v80, v112, v113
    v_cvt_pk_bf16_f32 v81, v114, v115
    v_cvt_pk_bf16_f32 v82, v116, v117
    v_cvt_pk_bf16_f32 v83, v118, v119
    buffer_store_dwordx4 v[80:83], v4, s[40:43], s37 offen sc0 sc1
    v_fma_f32 v120, v120, v16, v17
    v_fma_f32 v121, v121, v18, v19
    v_fma_f32 v122, v122, v20, v21
    v_fma_f32 v123, v123, v22, v23
    v_fma_f32 v124, v124, v24, v25
    v_fma_f32 v125, v125, v26, v27
    v_fma_f32 v126, v126, v28, v29
    v_fma_f32 v127, v127, v30, v31
    v_cvt_pk_bf16_f32 v84, v120, v121
    v_cvt_pk_bf16_f32 v85, v122, v123
    v_cvt_pk_bf16_f32 v86, v124, v125
    v_cvt_pk_bf16_f32 v87, v126, v127
    buffer_store_dwordx4 v[84:87], v5, s[40:43], s37 offen sc0 sc1
    s_lshr_b32 s35, s3, 1
    v_mov_b32 v112, 0
    v_mov_b32 v113, 0
    v_mov_b32 v114, 0
    v_mov_b32 v115, 0
    v_mov_b32 v116, 0
    v_mov_b32 v117, 0
    v_mov_b32 v118, 0
    v_mov_b32 v119, 0
    v_mov_b32 v120, 0
    v_mov_b32 v121, 0
    v_mov_b32 v122, 0
    v_mov_b32 v123, 0
    v_mov_b32 v124, 0
    v_mov_b32 v125, 0
    v_mov_b32 v126, 0
    v_mov_b32 v127, 0
    s_mov_b32 s38, 0
    s_mov_b32 s39, 0
    s_mov_b32 s37, 3
    s_barrier
    ds_read_b64_tr_b16 v[16:17], v9 offset:0
    ds_read_b64_tr_b16 v[18:19], v9 offset:512
    ds_read_b64_tr_b16 v[20:21], v9 offset:8192
    ds_read_b64_tr_b16 v[22:23], v9 offset:8704
    ds_read_b64_tr_b16 v[24:25], v9 offset:16384
    ds_read_b64_tr_b16 v[26:27], v9 offset:16896
    ds_read_b128 v[28:31], v10 offset:0
    ds_read_b128 v[32:35], v10 offset:2048
    ds_read_b128 v[36:39], v10 offset:4096
    ds_read_b128 v[40:43], v10 offset:6144
    ds_read_b128 v[44:47], v10 offset:8192
    ds_read_b128 v[48:51], v10 offset:10240
    ds_read_b128 v[52:55], v10 offset:12288
    ds_read_b128 v[56:59], v10 offset:14336
    ds_read_b128 v[60:63], v10 offset:16384
.p2align 6
L_c1loop:
    s_waitcnt lgkmcnt(0)
    v_mfma_f32_16x16x32_bf16 v[148:151], v[20:23], v[28:31], v[148:151]
    ds_read_b64_tr_b16 v[64:65], v9 offset:4096
    v_mfma_f32_16x16x32_bf16 v[184:187], v[24:27], v[28:31], v[184:187]
    ds_read_b64_tr_b16 v[66:67], v9 offset:4608
    v_mfma_f32_16x16x32_bf16 v[116:119], v[16:19], v[32:35], v[116:119]
    ds_read_b64_tr_b16 v[68:69], v9 offset:12288
    v_mfma_f32_16x16x32_bf16 v[152:155], v[20:23], v[32:35], v[152:155]
    ds_read_b64_tr_b16 v[70:71], v9 offset:12800
    v_mfma_f32_16x16x32_bf16 v[188:191], v[24:27], v[32:35], v[188:191]
    ds_read_b64_tr_b16 v[72:73], v9 offset:20480
    v_mfma_f32_16x16x32_bf16 v[120:123], v[16:19], v[36:39], v[120:123]
    ds_read_b64_tr_b16 v[74:75], v9 offset:20992
    v_mfma_f32_16x16x32_bf16 v[156:159], v[20:23], v[36:39], v[156:159]
    ds_read_b128 v[76:79], v11 offset:0
    v_mfma_f32_16x16x32_bf16 v[192:195], v[24:27], v[36:39], v[192:195]
    ds_read_b128 v[80:83], v11 offset:2048
    v_mfma_f32_16x16x32_bf16 v[124:127], v[16:19], v[40:43], v[124:127]
    ds_read_b128 v[84:87], v11 offset:4096
    v_mfma_f32_16x16x32_bf16 v[160:163], v[20:23], v[40:43], v[160:163]
    ds_read_b128 v[88:91], v11 offset:6144
    v_mfma_f32_16x16x32_bf16 v[196:199], v[24:27], v[40:43], v[196:199]
    ds_read_b128 v[92:95], v11 offset:8192
    v_mfma_f32_16x16x32_bf16 v[128:131], v[16:19], v[44:47], v[128:131]
    ds_read_b128 v[96:99], v11 offset:10240
    v_mfma_f32_16x16x32_bf16 v[164:167], v[20:23], v[44:47], v[164:167]
    ds_read_b128 v[100:103], v11 offset:12288
    v_mfma_f32_16x16x32_bf16 v[200:203], v[24:27], v[44:47], v[200:203]
    ds_read_b128 v[104:107], v11 offset:14336
    v_mfma_f32_16x16x32_bf16 v[132:135], v[16:19], v[48:51], v[132:135]
    ds_read_b128 v[108:111], v11 offset:16384
    v_mfma_f32_16x16x32_bf16 v[168:171], v[20:23], v[48:51], v[168:171]
    s_add_u32 s38, s38, 43008
    v_mfma_f32_16x16x32_bf16 v[204:207], v[24:27], v[48:51], v[204:207]
    s_cmp_eq_u32 s38, 129024
    v_mfma_f32_16x16x32_bf16 v[136:139], v[16:19], v[52:55], v[136:139]
    s_cselect_b32 s38, 0, s38
    v_mfma_f32_16x16x32_bf16 v[172:175], v[20:23], v[52:55], v[172:175]
    s_add_u32 s39, s39, 1
    v_mfma_f32_16x16x32_bf16 v[208:211], v[24:27], v[52:55], v[208:211]
    v_mfma_f32_16x16x32_bf16 v[140:143], v[16:19], v[56:59], v[140:143]
    v_mfma_f32_16x16x32_bf16 v[176:179], v[20:23], v[56:59], v[176:179]
    v_mfma_f32_16x16x32_bf16 v[212:215], v[24:27], v[56:59], v[212:215]
    v_mfma_f32_16x16x32_bf16 v[144:147], v[16:19], v[60:63], v[144:147]
    v_mfma_f32_16x16x32_bf16 v[180:183], v[20:23], v[60:63], v[180:183]
    v_mfma_f32_16x16x32_bf16 v[216:219], v[24:27], v[60:63], v[216:219]
    s_waitcnt lgkmcnt(0)
    s_barrier
    v_mfma_f32_16x16x32_bf16 v[148:151], v[68:71], v[76:79], v[148:151]
    v_add_u32 v9, s38, v12
    v_mfma_f32_16x16x32_bf16 v[184:187], v[72:75], v[76:79], v[184:187]
    v_add_u32 v10, s38, v13
    v_mfma_f32_16x16x32_bf16 v[116:119], v[64:67], v[80:83], v[116:119]
    ds_read_b64_tr_b16 v[16:17], v9 offset:0
    v_mfma_f32_16x16x32_bf16 v[152:155], v[68:71], v[80:83], v[152:155]
    ds_read_b64_tr_b16 v[18:19], v9 offset:512
    v_mfma_f32_16x16x32_bf16 v[188:191], v[72:75], v[80:83], v[188:191]
    ds_read_b64_tr_b16 v[20:21], v9 offset:8192
    v_mfma_f32_16x16x32_bf16 v[120:123], v[64:67], v[84:87], v[120:123]
    ds_read_b64_tr_b16 v[22:23], v9 offset:8704
    v_mfma_f32_16x16x32_bf16 v[156:159], v[68:71], v[84:87], v[156:159]
    ds_read_b64_tr_b16 v[24:25], v9 offset:16384
    v_mfma_f32_16x16x32_bf16 v[192:195], v[72:75], v[84:87], v[192:195]
    ds_read_b64_tr_b16 v[26:27], v9 offset:16896
    v_mfma_f32_16x16x32_bf16 v[124:127], v[64:67], v[88:91], v[124:127]
    ds_read_b128 v[28:31], v10 offset:0
    v_mfma_f32_16x16x32_bf16 v[160:163], v[68:71], v[88:91], v[160:163]
    ds_read_b128 v[32:35], v10 offset:2048
    v_mfma_f32_16x16x32_bf16 v[196:199], v[72:75], v[88:91], v[196:199]
    ds_read_b128 v[36:39], v10 offset:4096
    v_mfma_f32_16x16x32_bf16 v[128:131], v[64:67], v[92:95], v[128:131]
    ds_read_b128 v[40:43], v10 offset:6144
    v_mfma_f32_16x16x32_bf16 v[164:167], v[68:71], v[92:95], v[164:167]
    ds_read_b128 v[44:47], v10 offset:8192
    v_mfma_f32_16x16x32_bf16 v[200:203], v[72:75], v[92:95], v[200:203]
    ds_read_b128 v[48:51], v10 offset:10240
    v_mfma_f32_16x16x32_bf16 v[132:135], v[64:67], v[96:99], v[132:135]
    ds_read_b128 v[52:55], v10 offset:12288
    v_mfma_f32_16x16x32_bf16 v[168:171], v[68:71], v[96:99], v[168:171]
    ds_read_b128 v[56:59], v10 offset:14336
    v_mfma_f32_16x16x32_bf16 v[204:207], v[72:75], v[96:99], v[204:207]
    ds_read_b128 v[60:63], v10 offset:16384
    v_mfma_f32_16x16x32_bf16 v[136:139], v[64:67], v[100:103], v[136:139]
    v_add_u32 v11, s38, v14
    v_mfma_f32_16x16x32_bf16 v[172:175], v[68:71], v[100:103], v[172:175]
    s_cmp_lt_u32 s39, s37
    v_mfma_f32_16x16x32_bf16 v[208:211], v[72:75], v[100:103], v[208:211]
    v_mfma_f32_16x16x32_bf16 v[140:143], v[64:67], v[104:107], v[140:143]
    v_mfma_f32_16x16x32_bf16 v[176:179], v[68:71], v[104:107], v[176:179]
    v_mfma_f32_16x16x32_bf16 v[212:215], v[72:75], v[104:107], v[212:215]
    v_mfma_f32_16x16x32_bf16 v[144:147], v[64:67], v[108:111], v[144:147]
    v_mfma_f32_16x16x32_bf16 v[180:183], v[68:71], v[108:111], v[180:183]
    v_mfma_f32_16x16x32_bf16 v[216:219], v[72:75], v[108:111], v[216:219]
    s_cbranch_scc1 L_c1loop
    s_cmp_lg_u32 s39, 3
    s_cbranch_scc1 L_c1e0
    s_waitcnt vmcnt(0)
    s_and_b32 s37, s29, 3
    s_and_b32 s36, s28, 1
    s_lshl_b32 s36, s36, 1
    s_add_u32 s37, s37, s36
    s_add_u32 s37, s37, 4
    s_branch L_c1loop
L_c1e0:
    s_cmp_eq_u32 s39, 16
    s_cbranch_scc1 L_c1e1
    s_mov_b32 s37, 16
    s_cmp_lg_u32 s3, 0
    s_cbranch_scc1 L_c1loop
    v_mov_b32 v1, 1
    v_mov_b32 v2, 0
    s_mov_b64 exec, 1
    buffer_store_byte v1, v2, s[80:83], s2 offen sc0 sc1
    s_mov_b64 exec, -1
    s_branch L_c1loop
L_c1e1:
    s_waitcnt lgkmcnt(0)
    v_cvt_pk_bf16_f32 v16, v148, v149
    v_cvt_pk_bf16_f32 v17, v150, v151
    ds_write_b64 v235, v[16:17] offset:18432
    v_cvt_pk_bf16_f32 v18, v184, v185
    v_cvt_pk_bf16_f32 v19, v186, v187
    ds_write_b64 v235, v[18:19] offset:36864
    v_cvt_pk_bf16_f32 v20, v116, v117
    v_cvt_pk_bf16_f32 v21, v118, v119
    ds_write_b64 v236, v[20:21] offset:1024
    v_cvt_pk_bf16_f32 v22, v152, v153
    v_cvt_pk_bf16_f32 v23, v154, v155
    ds_write_b64 v236, v[22:23] offset:19456
    v_cvt_pk_bf16_f32 v24, v188, v189
    v_cvt_pk_bf16_f32 v25, v190, v191
    ds_write_b64 v236, v[24:25] offset:37888
    v_cvt_pk_bf16_f32 v26, v120, v121
    v_cvt_pk_bf16_f32 v27, v122, v123
    ds_write_b64 v235, v[26:27] offset:2048
    v_cvt_pk_bf16_f32 v28, v156, v157
    v_cvt_pk_bf16_f32 v29, v158, v159
    ds_write_b64 v235, v[28:29] offset:20480
    v_cvt_pk_bf16_f32 v30, v192, v193
    v_cvt_pk_bf16_f32 v31, v194, v195
    ds_write_b64 v235, v[30:31] offset:38912
    v_cvt_pk_bf16_f32 v16, v124, v125
    v_cvt_pk_bf16_f32 v17, v126, v127
    ds_write_b64 v236, v[16:17] offset:3072
    v_cvt_pk_bf16_f32 v18, v160, v161
    v_cvt_pk_bf16_f32 v19, v162, v163
    ds_write_b64 v236, v[18:19] offset:21504
    v_cvt_pk_bf16_f32 v20, v196, v197
    v_cvt_pk_bf16_f32 v21, v198, v199
    ds_write_b64 v236, v[20:21] offset:39936
    v_cvt_pk_bf16_f32 v22, v128, v129
    v_cvt_pk_bf16_f32 v23, v130, v131
    ds_write_b64 v235, v[22:23] offset:4096
    v_cvt_pk_bf16_f32 v24, v164, v165
    v_cvt_pk_bf16_f32 v25, v166, v167
    ds_write_b64 v235, v[24:25] offset:22528
    v_cvt_pk_bf16_f32 v26, v200, v201
    v_cvt_pk_bf16_f32 v27, v202, v203
    ds_write_b64 v235, v[26:27] offset:40960
    v_cvt_pk_bf16_f32 v28, v132, v133
    v_cvt_pk_bf16_f32 v29, v134, v135
    ds_write_b64 v236, v[28:29] offset:5120
    v_cvt_pk_bf16_f32 v30, v168, v169
    v_cvt_pk_bf16_f32 v31, v170, v171
    ds_write_b64 v236, v[30:31] offset:23552
    v_cvt_pk_bf16_f32 v16, v204, v205
    v_cvt_pk_bf16_f32 v17, v206, v207
    ds_write_b64 v236, v[16:17] offset:41984
    v_cvt_pk_bf16_f32 v18, v136, v137
    v_cvt_pk_bf16_f32 v19, v138, v139
    ds_write_b64 v235, v[18:19] offset:6144
    v_cvt_pk_bf16_f32 v20, v172, v173
    v_cvt_pk_bf16_f32 v21, v174, v175
    ds_write_b64 v235, v[20:21] offset:24576
    v_cvt_pk_bf16_f32 v22, v208, v209
    v_cvt_pk_bf16_f32 v23, v210, v211
    ds_write_b64 v235, v[22:23] offset:43008
    v_cvt_pk_bf16_f32 v24, v140, v141
    v_cvt_pk_bf16_f32 v25, v142, v143
    ds_write_b64 v236, v[24:25] offset:7168
    v_cvt_pk_bf16_f32 v26, v176, v177
    v_cvt_pk_bf16_f32 v27, v178, v179
    ds_write_b64 v236, v[26:27] offset:25600
    v_cvt_pk_bf16_f32 v28, v212, v213
    v_cvt_pk_bf16_f32 v29, v214, v215
    ds_write_b64 v236, v[28:29] offset:44032
    v_cvt_pk_bf16_f32 v30, v144, v145
    v_cvt_pk_bf16_f32 v31, v146, v147
    ds_write_b64 v235, v[30:31] offset:8192
    v_cvt_pk_bf16_f32 v16, v180, v181
    v_cvt_pk_bf16_f32 v17, v182, v183
    ds_write_b64 v235, v[16:17] offset:26624
    v_cvt_pk_bf16_f32 v18, v216, v217
    v_cvt_pk_bf16_f32 v19, v218, v219
    ds_write_b64 v235, v[18:19] offset:45056
    v_and_b32 v1, 15, v0
    v_add_u32 v1, s85, v1
    v_lshlrev_b32 v1, 2, v1
    s_mov_b32 s36, 16777216
    buffer_load_dword v212, v1, s[40:43], s36 offen offset:0 sc1
    buffer_load_dword v214, v1, s[40:43], s36 offen offset:64 sc1
    buffer_load_dword v216, v1, s[40:43], s36 offen offset:128 sc1
    buffer_load_dword v218, v1, s[40:43], s36 offen offset:192 sc1
    v_lshlrev_b32 v116, 16, v244
    v_and_b32 v117, 0xffff0000, v244
    v_lshlrev_b32 v118, 16, v245
    v_and_b32 v119, 0xffff0000, v245
    v_lshlrev_b32 v120, 16, v246
    v_and_b32 v121, 0xffff0000, v246
    v_lshlrev_b32 v122, 16, v247
    v_and_b32 v123, 0xffff0000, v247
    v_lshlrev_b32 v124, 16, v248
    v_and_b32 v125, 0xffff0000, v248
    v_lshlrev_b32 v126, 16, v249
    v_and_b32 v127, 0xffff0000, v249
    v_lshlrev_b32 v128, 16, v250
    v_and_b32 v129, 0xffff0000, v250
    v_lshlrev_b32 v130, 16, v251
    v_and_b32 v131, 0xffff0000, v251
    s_waitcnt lgkmcnt(0)
    s_barrier
    v_xor_b32 v8, 64, v237
    v_xor_b32 v9, 32, v238
    v_xor_b32 v10, 64, v238
    v_xor_b32 v11, 96, v238
    ds_read_b128 v[24:27], v237 offset:18432
    ds_read_b128 v[28:31], v237 offset:20480
    ds_read_b128 v[16:19], v237 offset:2048
    ds_read_b128 v[32:35], v8 offset:27648
    ds_read_b128 v[36:39], v8 offset:29696
    ds_read_b128 v[20:23], v8 offset:11264
    ds_read_b64_tr_b16 v[96:97], v238 offset:36864
    ds_read_b64_tr_b16 v[98:99], v238 offset:38912
    ds_read_b64_tr_b16 v[100:101], v9 offset:36864
    ds_read_b64_tr_b16 v[102:103], v9 offset:38912
    ds_read_b64_tr_b16 v[104:105], v10 offset:46080
    ds_read_b64_tr_b16 v[106:107], v10 offset:48128
    ds_read_b64_tr_b16 v[108:109], v11 offset:46080
    ds_read_b64_tr_b16 v[110:111], v11 offset:48128
    v_mov_b32 v12, 0xff800000
    v_mov_b32 v13, 0x3e8293ee
    s_waitcnt lgkmcnt(8)
    v_mfma_f32_16x16x32_bf16 v[48:51], v[24:27], v[16:19], 0
    v_mfma_f32_16x16x32_bf16 v[52:55], v[28:31], v[16:19], 0
    v_mfma_f32_16x16x32_bf16 v[56:59], v[32:35], v[20:23], 0
    v_mfma_f32_16x16x32_bf16 v[60:63], v[36:39], v[20:23], 0
    s_waitcnt lgkmcnt(0)
    s_barrier
    s_nop 5
    v_cndmask_b32 v48, v12, v48, s[12:13]
    v_cndmask_b32 v52, v12, v52, s[4:5]
    v_cndmask_b32 v49, v12, v49, s[14:15]
    v_cndmask_b32 v53, v12, v53, s[6:7]
    v_cndmask_b32 v50, v12, v50, s[16:17]
    v_cndmask_b32 v54, v12, v54, s[8:9]
    v_cndmask_b32 v51, v12, v51, s[18:19]
    v_cndmask_b32 v55, v12, v55, s[10:11]
    v_cndmask_b32 v56, v12, v56, s[12:13]
    v_cndmask_b32 v60, v12, v60, s[4:5]
    v_cndmask_b32 v57, v12, v57, s[14:15]
    v_cndmask_b32 v61, v12, v61, s[6:7]
    v_cndmask_b32 v58, v12, v58, s[16:17]
    v_cndmask_b32 v62, v12, v62, s[8:9]
    v_cndmask_b32 v59, v12, v59, s[18:19]
    v_cndmask_b32 v63, v12, v63, s[10:11]
    v_max3_f32 v64, v48, v49, v50
    v_max3_f32 v64, v64, v51, v52
    v_max3_f32 v64, v64, v53, v54
    v_max_f32 v64, v64, v55
    v_max3_f32 v65, v56, v57, v58
    v_max3_f32 v65, v65, v59, v60
    v_max3_f32 v65, v65, v61, v62
    v_max_f32 v65, v65, v63
    v_mov_b32 v66, v64
    v_mov_b32 v67, v65
    s_nop 1
    v_permlane16_swap_b32 v64, v66
    v_permlane16_swap_b32 v65, v67
    s_nop 1
    v_max_f32 v64, v64, v66
    v_max_f32 v65, v65, v67
    v_mov_b32 v66, v64
    v_mov_b32 v67, v65
    s_nop 1
    v_permlane32_swap_b32 v64, v66
    v_permlane32_swap_b32 v65, v67
    s_nop 1
    v_max_f32 v64, v64, v66
    v_max_f32 v65, v65, v67
    v_mul_f32 v64, v64, v13
    v_mul_f32 v65, v65, v13
    v_fma_f32 v48, v48, v13, -v64
    v_fma_f32 v49, v49, v13, -v64
    v_fma_f32 v50, v50, v13, -v64
    v_fma_f32 v51, v51, v13, -v64
    v_fma_f32 v52, v52, v13, -v64
    v_fma_f32 v53, v53, v13, -v64
    v_fma_f32 v54, v54, v13, -v64
    v_fma_f32 v55, v55, v13, -v64
    v_exp_f32 v48, v48
    v_exp_f32 v49, v49
    v_exp_f32 v50, v50
    v_exp_f32 v51, v51
    v_exp_f32 v52, v52
    v_exp_f32 v53, v53
    v_exp_f32 v54, v54
    v_exp_f32 v55, v55
    v_fma_f32 v56, v56, v13, -v65
    v_fma_f32 v57, v57, v13, -v65
    v_fma_f32 v58, v58, v13, -v65
    v_fma_f32 v59, v59, v13, -v65
    v_fma_f32 v60, v60, v13, -v65
    v_fma_f32 v61, v61, v13, -v65
    v_fma_f32 v62, v62, v13, -v65
    v_fma_f32 v63, v63, v13, -v65
    v_exp_f32 v56, v56
    v_exp_f32 v57, v57
    v_exp_f32 v58, v58
    v_exp_f32 v59, v59
    v_exp_f32 v60, v60
    v_exp_f32 v61, v61
    v_exp_f32 v62, v62
    v_exp_f32 v63, v63
    v_add_f32 v68, v48, v49
    v_add_f32 v68, v68, v50
    v_add_f32 v68, v68, v51
    v_add_f32 v68, v68, v52
    v_add_f32 v68, v68, v53
    v_add_f32 v68, v68, v54
    v_add_f32 v68, v68, v55
    v_add_f32 v69, v56, v57
    v_add_f32 v69, v69, v58
    v_add_f32 v69, v69, v59
    v_add_f32 v69, v69, v60
    v_add_f32 v69, v69, v61
    v_add_f32 v69, v69, v62
    v_add_f32 v69, v69, v63
    v_mov_b32 v66, v68
    v_mov_b32 v67, v69
    s_nop 1
    v_permlane16_swap_b32 v68, v66
    v_permlane16_swap_b32 v69, v67
    s_nop 1
    v_add_f32 v68, v68, v66
    v_add_f32 v69, v69, v67
    v_mov_b32 v66, v68
    v_mov_b32 v67, v69
    s_nop 1
    v_permlane32_swap_b32 v68, v66
    v_permlane32_swap_b32 v69, v67
    s_nop 1
    v_add_f32 v68, v68, v66
    v_add_f32 v69, v69, v67
    v_rcp_f32 v68, v68
    v_rcp_f32 v69, v69
    s_nop 0
    v_mul_f32 v48, v48, v68
    v_mul_f32 v49, v49, v68
    v_mul_f32 v50, v50, v68
    v_mul_f32 v51, v51, v68
    v_mul_f32 v52, v52, v68
    v_mul_f32 v53, v53, v68
    v_mul_f32 v54, v54, v68
    v_mul_f32 v55, v55, v68
    v_cvt_pk_bf16_f32 v72, v48, v49
    v_cvt_pk_bf16_f32 v73, v50, v51
    v_cvt_pk_bf16_f32 v74, v52, v53
    v_cvt_pk_bf16_f32 v75, v54, v55
    v_mul_f32 v56, v56, v69
    v_mul_f32 v57, v57, v69
    v_mul_f32 v58, v58, v69
    v_mul_f32 v59, v59, v69
    v_mul_f32 v60, v60, v69
    v_mul_f32 v61, v61, v69
    v_mul_f32 v62, v62, v69
    v_mul_f32 v63, v63, v69
    v_cvt_pk_bf16_f32 v76, v56, v57
    v_cvt_pk_bf16_f32 v77, v58, v59
    v_cvt_pk_bf16_f32 v78, v60, v61
    v_cvt_pk_bf16_f32 v79, v62, v63
    s_nop 1
    v_mfma_f32_16x16x32_bf16 v[80:83], v[96:99], v[72:75], 0
    v_mfma_f32_16x16x32_bf16 v[84:87], v[100:103], v[72:75], 0
    v_mfma_f32_16x16x32_bf16 v[88:91], v[104:107], v[76:79], 0
    v_mfma_f32_16x16x32_bf16 v[92:95], v[108:111], v[76:79], 0
    v_lshlrev_b32 v8, 4, v0
    s_nop 6
    v_cvt_pk_bf16_f32 v48, v80, v81
    v_cvt_pk_bf16_f32 v49, v82, v83
    v_cvt_pk_bf16_f32 v50, v84, v85
    v_cvt_pk_bf16_f32 v51, v86, v87
    ds_write_b128 v239, v[48:51] offset:0
    v_cvt_pk_bf16_f32 v52, v88, v89
    v_cvt_pk_bf16_f32 v53, v90, v91
    v_cvt_pk_bf16_f32 v54, v92, v93
    v_cvt_pk_bf16_f32 v55, v94, v95
    ds_write_b128 v239, v[52:55] offset:16
    s_waitcnt lgkmcnt(0)
    ds_read_b128 v[56:59], v240 offset:0
    ds_read_b128 v[60:63], v240 offset:1024
    s_waitcnt lgkmcnt(1)
    buffer_store_dwordx4 v[56:59], v8, s[40:43], s84 offen offset:0 sc0 sc1
    s_waitcnt lgkmcnt(0)
    buffer_store_dwordx4 v[60:63], v8, s[40:43], s84 offen offset:1024 sc0 sc1
    s_and_b32 s8, s28, 1
    s_bfe_u32 s4, s28, 0x10001
    s_lshl_b32 s4, s4, 3
    s_and_b32 s6, s29, 7
    s_add_u32 s4, s4, s6
    s_lshr_b32 s5, s28, 2
    s_lshl_b32 s5, s5, 2
    s_lshr_b32 s7, s29, 3
    s_add_u32 s5, s5, s7
    s_mov_b32 s38, 65536
    s_cmp_ge_u32 s29, 28
    s_cbranch_scc1 L_c_idle
    s_barrier
    v_add_u32 v76, s38, v220
    ds_read_b64_tr_b16 v[12:13], v76 offset:0
    ds_read_b64_tr_b16 v[14:15], v76 offset:1024
    v_add_u32 v77, s38, v221
    ds_read_b64_tr_b16 v[16:17], v77 offset:0
    ds_read_b64_tr_b16 v[18:19], v77 offset:1024
    v_add_u32 v78, s38, v222
    ds_read_b64_tr_b16 v[20:21], v78 offset:0
    ds_read_b64_tr_b16 v[22:23], v78 offset:1024
    v_add_u32 v79, s38, v223
    ds_read_b64_tr_b16 v[24:25], v79 offset:0
    ds_read_b64_tr_b16 v[26:27], v79 offset:1024
    v_add_u32 v80, s38, v224
    ds_read_b128 v[28:31], v80 offset:0
    ds_read_b128 v[32:35], v80 offset:1024
    ds_read_b128 v[36:39], v80 offset:2048
    ds_read_b128 v[40:43], v80 offset:3072
    s_waitcnt lgkmcnt(0)
    v_mfma_f32_16x16x32_bf16 v[148:151], v[12:15], v[28:31], v[116:119]
    ds_read_b64_tr_b16 v[44:45], v76 offset:8192
    v_mfma_f32_16x16x32_bf16 v[152:155], v[12:15], v[32:35], v[116:119]
    ds_read_b64_tr_b16 v[46:47], v76 offset:9216
    v_mfma_f32_16x16x32_bf16 v[156:159], v[12:15], v[36:39], v[116:119]
    ds_read_b64_tr_b16 v[48:49], v77 offset:8192
    v_mfma_f32_16x16x32_bf16 v[160:163], v[12:15], v[40:43], v[116:119]
    ds_read_b64_tr_b16 v[50:51], v77 offset:9216
    v_mfma_f32_16x16x32_bf16 v[164:167], v[16:19], v[28:31], v[120:123]
    ds_read_b64_tr_b16 v[52:53], v78 offset:8192
    v_mfma_f32_16x16x32_bf16 v[168:171], v[16:19], v[32:35], v[120:123]
    ds_read_b64_tr_b16 v[54:55], v78 offset:9216
    v_mfma_f32_16x16x32_bf16 v[172:175], v[16:19], v[36:39], v[120:123]
    ds_read_b64_tr_b16 v[56:57], v79 offset:8192
    v_mfma_f32_16x16x32_bf16 v[176:179], v[16:19], v[40:43], v[120:123]
    ds_read_b64_tr_b16 v[58:59], v79 offset:9216
    v_mfma_f32_16x16x32_bf16 v[180:183], v[20:23], v[28:31], v[124:127]
    ds_read_b128 v[60:63], v80 offset:8192
    v_mfma_f32_16x16x32_bf16 v[184:187], v[20:23], v[32:35], v[124:127]
    ds_read_b128 v[64:67], v80 offset:9216
    v_mfma_f32_16x16x32_bf16 v[188:191], v[20:23], v[36:39], v[124:127]
    ds_read_b128 v[68:71], v80 offset:10240
    v_mfma_f32_16x16x32_bf16 v[192:195], v[20:23], v[40:43], v[124:127]
    ds_read_b128 v[72:75], v80 offset:11264
    v_mfma_f32_16x16x32_bf16 v[196:199], v[24:27], v[28:31], v[128:131]
    s_add_u32 s38, s38, 32768
    v_mfma_f32_16x16x32_bf16 v[200:203], v[24:27], v[32:35], v[128:131]
    s_cmp_eq_u32 s38, 163840
    v_mfma_f32_16x16x32_bf16 v[204:207], v[24:27], v[36:39], v[128:131]
    s_cselect_b32 s38, 0, s38
    v_mfma_f32_16x16x32_bf16 v[208:211], v[24:27], v[40:43], v[128:131]
    s_waitcnt lgkmcnt(0)
    s_barrier
    v_mfma_f32_16x16x32_bf16 v[148:151], v[44:47], v[60:63], v[148:151]
    v_add_u32 v76, s38, v220
    ds_read_b64_tr_b16 v[12:13], v76 offset:0
    v_mfma_f32_16x16x32_bf16 v[152:155], v[44:47], v[64:67], v[152:155]
    ds_read_b64_tr_b16 v[14:15], v76 offset:1024
    v_mfma_f32_16x16x32_bf16 v[156:159], v[44:47], v[68:71], v[156:159]
    v_add_u32 v77, s38, v221
    v_mfma_f32_16x16x32_bf16 v[160:163], v[44:47], v[72:75], v[160:163]
    ds_read_b64_tr_b16 v[16:17], v77 offset:0
    v_mfma_f32_16x16x32_bf16 v[164:167], v[48:51], v[60:63], v[164:167]
    ds_read_b64_tr_b16 v[18:19], v77 offset:1024
    v_mfma_f32_16x16x32_bf16 v[168:171], v[48:51], v[64:67], v[168:171]
    v_add_u32 v78, s38, v222
    v_mfma_f32_16x16x32_bf16 v[172:175], v[48:51], v[68:71], v[172:175]
    ds_read_b64_tr_b16 v[20:21], v78 offset:0
    v_mfma_f32_16x16x32_bf16 v[176:179], v[48:51], v[72:75], v[176:179]
    ds_read_b64_tr_b16 v[22:23], v78 offset:1024
    v_mfma_f32_16x16x32_bf16 v[180:183], v[52:55], v[60:63], v[180:183]
    v_add_u32 v79, s38, v223
    v_mfma_f32_16x16x32_bf16 v[184:187], v[52:55], v[64:67], v[184:187]
    ds_read_b64_tr_b16 v[24:25], v79 offset:0
    v_mfma_f32_16x16x32_bf16 v[188:191], v[52:55], v[68:71], v[188:191]
    ds_read_b64_tr_b16 v[26:27], v79 offset:1024
    v_mfma_f32_16x16x32_bf16 v[192:195], v[52:55], v[72:75], v[192:195]
    v_add_u32 v80, s38, v224
    v_mfma_f32_16x16x32_bf16 v[196:199], v[56:59], v[60:63], v[196:199]
    ds_read_b128 v[28:31], v80 offset:0
    v_mfma_f32_16x16x32_bf16 v[200:203], v[56:59], v[64:67], v[200:203]
    ds_read_b128 v[32:35], v80 offset:1024
    v_mfma_f32_16x16x32_bf16 v[204:207], v[56:59], v[68:71], v[204:207]
    ds_read_b128 v[36:39], v80 offset:2048
    v_mfma_f32_16x16x32_bf16 v[208:211], v[56:59], v[72:75], v[208:211]
    ds_read_b128 v[40:43], v80 offset:3072
    s_mov_b32 s39, 0
    s_mov_b32 s33, 1
.p2align 6
L_c2loop:
    s_waitcnt lgkmcnt(0)
    v_mfma_f32_16x16x32_bf16 v[148:151], v[12:15], v[28:31], v[148:151]
    ds_read_b64_tr_b16 v[44:45], v76 offset:8192
    v_mfma_f32_16x16x32_bf16 v[152:155], v[12:15], v[32:35], v[152:155]
    ds_read_b64_tr_b16 v[46:47], v76 offset:9216
    v_mfma_f32_16x16x32_bf16 v[156:159], v[12:15], v[36:39], v[156:159]
    ds_read_b64_tr_b16 v[48:49], v77 offset:8192
    v_mfma_f32_16x16x32_bf16 v[160:163], v[12:15], v[40:43], v[160:163]
    ds_read_b64_tr_b16 v[50:51], v77 offset:9216
    v_mfma_f32_16x16x32_bf16 v[164:167], v[16:19], v[28:31], v[164:167]
    ds_read_b64_tr_b16 v[52:53], v78 offset:8192
    v_mfma_f32_16x16x32_bf16 v[168:171], v[16:19], v[32:35], v[168:171]
    ds_read_b64_tr_b16 v[54:55], v78 offset:9216
    v_mfma_f32_16x16x32_bf16 v[172:175], v[16:19], v[36:39], v[172:175]
    ds_read_b64_tr_b16 v[56:57], v79 offset:8192
    v_mfma_f32_16x16x32_bf16 v[176:179], v[16:19], v[40:43], v[176:179]
    ds_read_b64_tr_b16 v[58:59], v79 offset:9216
    v_mfma_f32_16x16x32_bf16 v[180:183], v[20:23], v[28:31], v[180:183]
    ds_read_b128 v[60:63], v80 offset:8192
    v_mfma_f32_16x16x32_bf16 v[184:187], v[20:23], v[32:35], v[184:187]
    ds_read_b128 v[64:67], v80 offset:9216
    v_mfma_f32_16x16x32_bf16 v[188:191], v[20:23], v[36:39], v[188:191]
    ds_read_b128 v[68:71], v80 offset:10240
    v_mfma_f32_16x16x32_bf16 v[192:195], v[20:23], v[40:43], v[192:195]
    ds_read_b128 v[72:75], v80 offset:11264
    v_mfma_f32_16x16x32_bf16 v[196:199], v[24:27], v[28:31], v[196:199]
    s_add_u32 s38, s38, 32768
    v_mfma_f32_16x16x32_bf16 v[200:203], v[24:27], v[32:35], v[200:203]
    s_cmp_eq_u32 s38, 163840
    v_mfma_f32_16x16x32_bf16 v[204:207], v[24:27], v[36:39], v[204:207]
    s_cselect_b32 s38, 0, s38
    v_mfma_f32_16x16x32_bf16 v[208:211], v[24:27], v[40:43], v[208:211]
    s_waitcnt lgkmcnt(0)
    s_barrier
    v_mfma_f32_16x16x32_bf16 v[148:151], v[44:47], v[60:63], v[148:151]
    v_add_u32 v76, s38, v220
    ds_read_b64_tr_b16 v[12:13], v76 offset:0
    v_mfma_f32_16x16x32_bf16 v[152:155], v[44:47], v[64:67], v[152:155]
    ds_read_b64_tr_b16 v[14:15], v76 offset:1024
    v_add_u32 v77, s38, v221
    v_mfma_f32_16x16x32_bf16 v[156:159], v[44:47], v[68:71], v[156:159]
    ds_read_b64_tr_b16 v[16:17], v77 offset:0
    v_mfma_f32_16x16x32_bf16 v[160:163], v[44:47], v[72:75], v[160:163]
    ds_read_b64_tr_b16 v[18:19], v77 offset:1024
    v_mfma_f32_16x16x32_bf16 v[164:167], v[48:51], v[60:63], v[164:167]
    v_add_u32 v78, s38, v222
    v_mfma_f32_16x16x32_bf16 v[168:171], v[48:51], v[64:67], v[168:171]
    ds_read_b64_tr_b16 v[20:21], v78 offset:0
    v_mfma_f32_16x16x32_bf16 v[172:175], v[48:51], v[68:71], v[172:175]
    ds_read_b64_tr_b16 v[22:23], v78 offset:1024
    v_mfma_f32_16x16x32_bf16 v[176:179], v[48:51], v[72:75], v[176:179]
    v_add_u32 v79, s38, v223
    v_mfma_f32_16x16x32_bf16 v[180:183], v[52:55], v[60:63], v[180:183]
    ds_read_b64_tr_b16 v[24:25], v79 offset:0
    v_mfma_f32_16x16x32_bf16 v[184:187], v[52:55], v[64:67], v[184:187]
    ds_read_b64_tr_b16 v[26:27], v79 offset:1024
    v_mfma_f32_16x16x32_bf16 v[188:191], v[52:55], v[68:71], v[188:191]
    v_add_u32 v80, s38, v224
    v_mfma_f32_16x16x32_bf16 v[192:195], v[52:55], v[72:75], v[192:195]
    ds_read_b128 v[28:31], v80 offset:0
    v_mfma_f32_16x16x32_bf16 v[196:199], v[56:59], v[60:63], v[196:199]
    ds_read_b128 v[32:35], v80 offset:1024
    v_mfma_f32_16x16x32_bf16 v[200:203], v[56:59], v[64:67], v[200:203]
    ds_read_b128 v[36:39], v80 offset:2048
    v_mfma_f32_16x16x32_bf16 v[204:207], v[56:59], v[68:71], v[204:207]
    ds_read_b128 v[40:43], v80 offset:3072
    v_mfma_f32_16x16x32_bf16 v[208:211], v[56:59], v[72:75], v[208:211]
    s_add_u32 s39, s39, 1
    s_cmp_lt_u32 s39, s33
    s_cbranch_scc1 L_c2loop
    s_cmp_lg_u32 s39, 1
    s_cbranch_scc1 L_c2loop_e0
    s_waitcnt vmcnt(0)
    s_mov_b32 s33, 2
    s_branch L_c2loop
L_c2loop_e0:
    s_cmp_lg_u32 s39, 2
    s_cbranch_scc1 L_c2loop_e1
    s_cmp_lg_u32 s3, 0
    s_cbranch_scc1 L_cpo
    v_mov_b32 v1, 1
    s_mov_b64 exec, 0xff
    buffer_store_dword v1, v241, s[40:43], 0 offen sc0 sc1
    s_mov_b64 exec, -1
L_cpo:
    s_mov_b32 s33, 30
    s_branch L_c2loop
L_c2loop_e1:
    s_waitcnt lgkmcnt(0)
    v_mfma_f32_16x16x32_bf16 v[148:151], v[12:15], v[28:31], v[148:151]
    ds_read_b64_tr_b16 v[44:45], v76 offset:8192
    v_mfma_f32_16x16x32_bf16 v[152:155], v[12:15], v[32:35], v[152:155]
    ds_read_b64_tr_b16 v[46:47], v76 offset:9216
    v_mfma_f32_16x16x32_bf16 v[156:159], v[12:15], v[36:39], v[156:159]
    ds_read_b64_tr_b16 v[48:49], v77 offset:8192
    v_mfma_f32_16x16x32_bf16 v[160:163], v[12:15], v[40:43], v[160:163]
    ds_read_b64_tr_b16 v[50:51], v77 offset:9216
    v_mfma_f32_16x16x32_bf16 v[164:167], v[16:19], v[28:31], v[164:167]
    ds_read_b64_tr_b16 v[52:53], v78 offset:8192
    v_mfma_f32_16x16x32_bf16 v[168:171], v[16:19], v[32:35], v[168:171]
    ds_read_b64_tr_b16 v[54:55], v78 offset:9216
    v_mfma_f32_16x16x32_bf16 v[172:175], v[16:19], v[36:39], v[172:175]
    ds_read_b64_tr_b16 v[56:57], v79 offset:8192
    v_mfma_f32_16x16x32_bf16 v[176:179], v[16:19], v[40:43], v[176:179]
    ds_read_b64_tr_b16 v[58:59], v79 offset:9216
    v_mfma_f32_16x16x32_bf16 v[180:183], v[20:23], v[28:31], v[180:183]
    ds_read_b128 v[60:63], v80 offset:8192
    v_mfma_f32_16x16x32_bf16 v[184:187], v[20:23], v[32:35], v[184:187]
    ds_read_b128 v[64:67], v80 offset:9216
    v_mfma_f32_16x16x32_bf16 v[188:191], v[20:23], v[36:39], v[188:191]
    ds_read_b128 v[68:71], v80 offset:10240
    v_mfma_f32_16x16x32_bf16 v[192:195], v[20:23], v[40:43], v[192:195]
    ds_read_b128 v[72:75], v80 offset:11264
    v_mfma_f32_16x16x32_bf16 v[196:199], v[24:27], v[28:31], v[196:199]
    s_add_u32 s38, s38, 32768
    v_mfma_f32_16x16x32_bf16 v[200:203], v[24:27], v[32:35], v[200:203]
    s_cmp_eq_u32 s38, 163840
    v_mfma_f32_16x16x32_bf16 v[204:207], v[24:27], v[36:39], v[204:207]
    s_cselect_b32 s38, 0, s38
    v_mfma_f32_16x16x32_bf16 v[208:211], v[24:27], v[40:43], v[208:211]
    s_waitcnt lgkmcnt(0)
    s_barrier
    v_mfma_f32_16x16x32_bf16 v[148:151], v[44:47], v[60:63], v[148:151]
    v_add_u32 v76, s38, v225
    ds_read_b64_tr_b16 v[12:13], v76 offset:0
    v_mfma_f32_16x16x32_bf16 v[152:155], v[44:47], v[64:67], v[152:155]
    ds_read_b64_tr_b16 v[14:15], v76 offset:4096
    v_mfma_f32_16x16x32_bf16 v[156:159], v[44:47], v[68:71], v[156:159]
    v_add_u32 v77, s38, v226
    v_mfma_f32_16x16x32_bf16 v[160:163], v[44:47], v[72:75], v[160:163]
    ds_read_b64_tr_b16 v[16:17], v77 offset:0
    v_mfma_f32_16x16x32_bf16 v[164:167], v[48:51], v[60:63], v[164:167]
    ds_read_b64_tr_b16 v[18:19], v77 offset:4096
    v_mfma_f32_16x16x32_bf16 v[168:171], v[48:51], v[64:67], v[168:171]
    v_add_u32 v78, s38, v227
    v_mfma_f32_16x16x32_bf16 v[172:175], v[48:51], v[68:71], v[172:175]
    ds_read_b64_tr_b16 v[20:21], v78 offset:0
    v_mfma_f32_16x16x32_bf16 v[176:179], v[48:51], v[72:75], v[176:179]
    ds_read_b64_tr_b16 v[22:23], v78 offset:4096
    v_mfma_f32_16x16x32_bf16 v[180:183], v[52:55], v[60:63], v[180:183]
    v_add_u32 v79, s38, v228
    v_mfma_f32_16x16x32_bf16 v[184:187], v[52:55], v[64:67], v[184:187]
    ds_read_b64_tr_b16 v[24:25], v79 offset:0
    v_mfma_f32_16x16x32_bf16 v[188:191], v[52:55], v[68:71], v[188:191]
    ds_read_b64_tr_b16 v[26:27], v79 offset:4096
    v_mfma_f32_16x16x32_bf16 v[192:195], v[52:55], v[72:75], v[192:195]
    v_add_u32 v80, s38, v229
    v_mfma_f32_16x16x32_bf16 v[196:199], v[56:59], v[60:63], v[196:199]
    ds_read_b128 v[28:31], v80 offset:0
    v_mfma_f32_16x16x32_bf16 v[200:203], v[56:59], v[64:67], v[200:203]
    ds_read_b128 v[32:35], v80 offset:1024
    v_mfma_f32_16x16x32_bf16 v[204:207], v[56:59], v[68:71], v[204:207]
    ds_read_b128 v[36:39], v80 offset:2048
    v_mfma_f32_16x16x32_bf16 v[208:211], v[56:59], v[72:75], v[208:211]
    ds_read_b128 v[40:43], v80 offset:3072
    v_lshlrev_b32 v1, 4, v0
    v_mov_b32 v44, 0xc0135761
    v_mov_b32 v45, 0xc0135761
    v_mov_b32 v46, 0xbdd2d3e8
    v_mov_b32 v47, 0xbdd2d3e8
    v_mov_b32 v48, 0x3f800000
    v_mov_b32 v49, 0x3f800000
    s_mul_i32 s36, s30, 917504
    s_lshl_b32 s37, s31, 15
    s_add_u32 s36, s36, s37
    s_lshl_b32 s37, s34, 14
    s_add_u32 s36, s36, s37
    s_lshl_b32 s37, s35, 12
    s_add_u32 s36, s36, s37
    s_add_u32 s36, s36, 4194304
    v_pk_mul_f32 v[84:85], v[148:149], v[148:149]
    v_pk_fma_f32 v[84:85], v[84:85], v[46:47], v[44:45]
    v_pk_mul_f32 v[84:85], v[84:85], v[148:149]
    v_pk_mul_f32 v[86:87], v[150:151], v[150:151]
    v_pk_fma_f32 v[86:87], v[86:87], v[46:47], v[44:45]
    v_pk_mul_f32 v[86:87], v[86:87], v[150:151]
    v_pk_mul_f32 v[88:89], v[164:165], v[164:165]
    v_pk_fma_f32 v[88:89], v[88:89], v[46:47], v[44:45]
    v_pk_mul_f32 v[88:89], v[88:89], v[164:165]
    v_pk_mul_f32 v[90:91], v[166:167], v[166:167]
    v_pk_fma_f32 v[90:91], v[90:91], v[46:47], v[44:45]
    v_pk_mul_f32 v[90:91], v[90:91], v[166:167]
    v_exp_f32 v84, v84
    v_exp_f32 v85, v85
    v_exp_f32 v86, v86
    v_exp_f32 v87, v87
    v_exp_f32 v88, v88
    v_exp_f32 v89, v89
    v_exp_f32 v90, v90
    v_exp_f32 v91, v91
    v_pk_add_f32 v[84:85], v[84:85], v[48:49]
    v_pk_add_f32 v[86:87], v[86:87], v[48:49]
    v_pk_add_f32 v[88:89], v[88:89], v[48:49]
    v_pk_add_f32 v[90:91], v[90:91], v[48:49]
    v_rcp_f32 v84, v84
    v_rcp_f32 v85, v85
    v_rcp_f32 v86, v86
    v_rcp_f32 v87, v87
    v_rcp_f32 v88, v88
    v_rcp_f32 v89, v89
    v_rcp_f32 v90, v90
    v_rcp_f32 v91, v91
    v_pk_mul_f32 v[84:85], v[84:85], v[148:149]
    v_pk_mul_f32 v[86:87], v[86:87], v[150:151]
    v_pk_mul_f32 v[88:89], v[88:89], v[164:165]
    v_pk_mul_f32 v[90:91], v[90:91], v[166:167]
    v_cvt_pk_bf16_f32 v92, v84, v85
    v_cvt_pk_bf16_f32 v93, v86, v87
    v_cvt_pk_bf16_f32 v94, v88, v89
    v_cvt_pk_bf16_f32 v95, v90, v91
    s_add_u32 s37, s36, 0
    buffer_store_dwordx4 v[92:95], v1, s[40:43], s37 offen sc0 sc1
    v_pk_mul_f32 v[96:97], v[152:153], v[152:153]
    v_pk_fma_f32 v[96:97], v[96:97], v[46:47], v[44:45]
    v_pk_mul_f32 v[96:97], v[96:97], v[152:153]
    v_pk_mul_f32 v[98:99], v[154:155], v[154:155]
    v_pk_fma_f32 v[98:99], v[98:99], v[46:47], v[44:45]
    v_pk_mul_f32 v[98:99], v[98:99], v[154:155]
    v_pk_mul_f32 v[100:101], v[168:169], v[168:169]
    v_pk_fma_f32 v[100:101], v[100:101], v[46:47], v[44:45]
    v_pk_mul_f32 v[100:101], v[100:101], v[168:169]
    v_pk_mul_f32 v[102:103], v[170:171], v[170:171]
    v_pk_fma_f32 v[102:103], v[102:103], v[46:47], v[44:45]
    v_pk_mul_f32 v[102:103], v[102:103], v[170:171]
    v_exp_f32 v96, v96
    v_exp_f32 v97, v97
    v_exp_f32 v98, v98
    v_exp_f32 v99, v99
    v_exp_f32 v100, v100
    v_exp_f32 v101, v101
    v_exp_f32 v102, v102
    v_exp_f32 v103, v103
    v_pk_add_f32 v[96:97], v[96:97], v[48:49]
    v_pk_add_f32 v[98:99], v[98:99], v[48:49]
    v_pk_add_f32 v[100:101], v[100:101], v[48:49]
    v_pk_add_f32 v[102:103], v[102:103], v[48:49]
    v_rcp_f32 v96, v96
    v_rcp_f32 v97, v97
    v_rcp_f32 v98, v98
    v_rcp_f32 v99, v99
    v_rcp_f32 v100, v100
    v_rcp_f32 v101, v101
    v_rcp_f32 v102, v102
    v_rcp_f32 v103, v103
    v_pk_mul_f32 v[96:97], v[96:97], v[152:153]
    v_pk_mul_f32 v[98:99], v[98:99], v[154:155]
    v_pk_mul_f32 v[100:101], v[100:101], v[168:169]
    v_pk_mul_f32 v[102:103], v[102:103], v[170:171]
    v_cvt_pk_bf16_f32 v104, v96, v97
    v_cvt_pk_bf16_f32 v105, v98, v99
    v_cvt_pk_bf16_f32 v106, v100, v101
    v_cvt_pk_bf16_f32 v107, v102, v103
    s_add_u32 s37, s36, 1024
    buffer_store_dwordx4 v[104:107], v1, s[40:43], s37 offen sc0 sc1
    v_pk_mul_f32 v[108:109], v[156:157], v[156:157]
    v_pk_fma_f32 v[108:109], v[108:109], v[46:47], v[44:45]
    v_pk_mul_f32 v[108:109], v[108:109], v[156:157]
    v_pk_mul_f32 v[110:111], v[158:159], v[158:159]
    v_pk_fma_f32 v[110:111], v[110:111], v[46:47], v[44:45]
    v_pk_mul_f32 v[110:111], v[110:111], v[158:159]
    v_pk_mul_f32 v[112:113], v[172:173], v[172:173]
    v_pk_fma_f32 v[112:113], v[112:113], v[46:47], v[44:45]
    v_pk_mul_f32 v[112:113], v[112:113], v[172:173]
    v_pk_mul_f32 v[114:115], v[174:175], v[174:175]
    v_pk_fma_f32 v[114:115], v[114:115], v[46:47], v[44:45]
    v_pk_mul_f32 v[114:115], v[114:115], v[174:175]
    v_exp_f32 v108, v108
    v_exp_f32 v109, v109
    v_exp_f32 v110, v110
    v_exp_f32 v111, v111
    v_exp_f32 v112, v112
    v_exp_f32 v113, v113
    v_exp_f32 v114, v114
    v_exp_f32 v115, v115
    v_pk_add_f32 v[108:109], v[108:109], v[48:49]
    v_pk_add_f32 v[110:111], v[110:111], v[48:49]
    v_pk_add_f32 v[112:113], v[112:113], v[48:49]
    v_pk_add_f32 v[114:115], v[114:115], v[48:49]
    v_rcp_f32 v108, v108
    v_rcp_f32 v109, v109
    v_rcp_f32 v110, v110
    v_rcp_f32 v111, v111
    v_rcp_f32 v112, v112
    v_rcp_f32 v113, v113
    v_rcp_f32 v114, v114
    v_rcp_f32 v115, v115
    v_pk_mul_f32 v[108:109], v[108:109], v[156:157]
    v_pk_mul_f32 v[110:111], v[110:111], v[158:159]
    v_pk_mul_f32 v[112:113], v[112:113], v[172:173]
    v_pk_mul_f32 v[114:115], v[114:115], v[174:175]
    v_cvt_pk_bf16_f32 v116, v108, v109
    v_cvt_pk_bf16_f32 v117, v110, v111
    v_cvt_pk_bf16_f32 v118, v112, v113
    v_cvt_pk_bf16_f32 v119, v114, v115
    s_add_u32 s37, s36, 2048
    buffer_store_dwordx4 v[116:119], v1, s[40:43], s37 offen sc0 sc1
    v_pk_mul_f32 v[120:121], v[160:161], v[160:161]
    v_pk_fma_f32 v[120:121], v[120:121], v[46:47], v[44:45]
    v_pk_mul_f32 v[120:121], v[120:121], v[160:161]
    v_pk_mul_f32 v[122:123], v[162:163], v[162:163]
    v_pk_fma_f32 v[122:123], v[122:123], v[46:47], v[44:45]
    v_pk_mul_f32 v[122:123], v[122:123], v[162:163]
    v_pk_mul_f32 v[124:125], v[176:177], v[176:177]
    v_pk_fma_f32 v[124:125], v[124:125], v[46:47], v[44:45]
    v_pk_mul_f32 v[124:125], v[124:125], v[176:177]
    v_pk_mul_f32 v[126:127], v[178:179], v[178:179]
    v_pk_fma_f32 v[126:127], v[126:127], v[46:47], v[44:45]
    v_pk_mul_f32 v[126:127], v[126:127], v[178:179]
    v_exp_f32 v120, v120
    v_exp_f32 v121, v121
    v_exp_f32 v122, v122
    v_exp_f32 v123, v123
    v_exp_f32 v124, v124
    v_exp_f32 v125, v125
    v_exp_f32 v126, v126
    v_exp_f32 v127, v127
    v_pk_add_f32 v[120:121], v[120:121], v[48:49]
    v_pk_add_f32 v[122:123], v[122:123], v[48:49]
    v_pk_add_f32 v[124:125], v[124:125], v[48:49]
    v_pk_add_f32 v[126:127], v[126:127], v[48:49]
    v_rcp_f32 v120, v120
    v_rcp_f32 v121, v121
    v_rcp_f32 v122, v122
    v_rcp_f32 v123, v123
    v_rcp_f32 v124, v124
    v_rcp_f32 v125, v125
    v_rcp_f32 v126, v126
    v_rcp_f32 v127, v127
    v_pk_mul_f32 v[120:121], v[120:121], v[160:161]
    v_pk_mul_f32 v[122:123], v[122:123], v[162:163]
    v_pk_mul_f32 v[124:125], v[124:125], v[176:177]
    v_pk_mul_f32 v[126:127], v[126:127], v[178:179]
    v_cvt_pk_bf16_f32 v128, v120, v121
    v_cvt_pk_bf16_f32 v129, v122, v123
    v_cvt_pk_bf16_f32 v130, v124, v125
    v_cvt_pk_bf16_f32 v131, v126, v127
    s_add_u32 s37, s36, 3072
    buffer_store_dwordx4 v[128:131], v1, s[40:43], s37 offen sc0 sc1
    v_pk_mul_f32 v[84:85], v[180:181], v[180:181]
    v_pk_fma_f32 v[84:85], v[84:85], v[46:47], v[44:45]
    v_pk_mul_f32 v[84:85], v[84:85], v[180:181]
    v_pk_mul_f32 v[86:87], v[182:183], v[182:183]
    v_pk_fma_f32 v[86:87], v[86:87], v[46:47], v[44:45]
    v_pk_mul_f32 v[86:87], v[86:87], v[182:183]
    v_pk_mul_f32 v[88:89], v[196:197], v[196:197]
    v_pk_fma_f32 v[88:89], v[88:89], v[46:47], v[44:45]
    v_pk_mul_f32 v[88:89], v[88:89], v[196:197]
    v_pk_mul_f32 v[90:91], v[198:199], v[198:199]
    v_pk_fma_f32 v[90:91], v[90:91], v[46:47], v[44:45]
    v_pk_mul_f32 v[90:91], v[90:91], v[198:199]
    v_exp_f32 v84, v84
    v_exp_f32 v85, v85
    v_exp_f32 v86, v86
    v_exp_f32 v87, v87
    v_exp_f32 v88, v88
    v_exp_f32 v89, v89
    v_exp_f32 v90, v90
    v_exp_f32 v91, v91
    v_pk_add_f32 v[84:85], v[84:85], v[48:49]
    v_pk_add_f32 v[86:87], v[86:87], v[48:49]
    v_pk_add_f32 v[88:89], v[88:89], v[48:49]
    v_pk_add_f32 v[90:91], v[90:91], v[48:49]
    v_rcp_f32 v84, v84
    v_rcp_f32 v85, v85
    v_rcp_f32 v86, v86
    v_rcp_f32 v87, v87
    v_rcp_f32 v88, v88
    v_rcp_f32 v89, v89
    v_rcp_f32 v90, v90
    v_rcp_f32 v91, v91
    v_pk_mul_f32 v[84:85], v[84:85], v[180:181]
    v_pk_mul_f32 v[86:87], v[86:87], v[182:183]
    v_pk_mul_f32 v[88:89], v[88:89], v[196:197]
    v_pk_mul_f32 v[90:91], v[90:91], v[198:199]
    v_cvt_pk_bf16_f32 v92, v84, v85
    v_cvt_pk_bf16_f32 v93, v86, v87
    v_cvt_pk_bf16_f32 v94, v88, v89
    v_cvt_pk_bf16_f32 v95, v90, v91
    s_add_u32 s37, s36, 8192
    buffer_store_dwordx4 v[92:95], v1, s[40:43], s37 offen sc0 sc1
    v_pk_mul_f32 v[96:97], v[184:185], v[184:185]
    v_pk_fma_f32 v[96:97], v[96:97], v[46:47], v[44:45]
    v_pk_mul_f32 v[96:97], v[96:97], v[184:185]
    v_pk_mul_f32 v[98:99], v[186:187], v[186:187]
    v_pk_fma_f32 v[98:99], v[98:99], v[46:47], v[44:45]
    v_pk_mul_f32 v[98:99], v[98:99], v[186:187]
    v_pk_mul_f32 v[100:101], v[200:201], v[200:201]
    v_pk_fma_f32 v[100:101], v[100:101], v[46:47], v[44:45]
    v_pk_mul_f32 v[100:101], v[100:101], v[200:201]
    v_pk_mul_f32 v[102:103], v[202:203], v[202:203]
    v_pk_fma_f32 v[102:103], v[102:103], v[46:47], v[44:45]
    v_pk_mul_f32 v[102:103], v[102:103], v[202:203]
    v_exp_f32 v96, v96
    v_exp_f32 v97, v97
    v_exp_f32 v98, v98
    v_exp_f32 v99, v99
    v_exp_f32 v100, v100
    v_exp_f32 v101, v101
    v_exp_f32 v102, v102
    v_exp_f32 v103, v103
    v_pk_add_f32 v[96:97], v[96:97], v[48:49]
    v_pk_add_f32 v[98:99], v[98:99], v[48:49]
    v_pk_add_f32 v[100:101], v[100:101], v[48:49]
    v_pk_add_f32 v[102:103], v[102:103], v[48:49]
    v_rcp_f32 v96, v96
    v_rcp_f32 v97, v97
    v_rcp_f32 v98, v98
    v_rcp_f32 v99, v99
    v_rcp_f32 v100, v100
    v_rcp_f32 v101, v101
    v_rcp_f32 v102, v102
    v_rcp_f32 v103, v103
    v_pk_mul_f32 v[96:97], v[96:97], v[184:185]
    v_pk_mul_f32 v[98:99], v[98:99], v[186:187]
    v_pk_mul_f32 v[100:101], v[100:101], v[200:201]
    v_pk_mul_f32 v[102:103], v[102:103], v[202:203]
    v_cvt_pk_bf16_f32 v104, v96, v97
    v_cvt_pk_bf16_f32 v105, v98, v99
    v_cvt_pk_bf16_f32 v106, v100, v101
    v_cvt_pk_bf16_f32 v107, v102, v103
    s_add_u32 s37, s36, 9216
    buffer_store_dwordx4 v[104:107], v1, s[40:43], s37 offen sc0 sc1
    v_pk_mul_f32 v[108:109], v[188:189], v[188:189]
    v_pk_fma_f32 v[108:109], v[108:109], v[46:47], v[44:45]
    v_pk_mul_f32 v[108:109], v[108:109], v[188:189]
    v_pk_mul_f32 v[110:111], v[190:191], v[190:191]
    v_pk_fma_f32 v[110:111], v[110:111], v[46:47], v[44:45]
    v_pk_mul_f32 v[110:111], v[110:111], v[190:191]
    v_pk_mul_f32 v[112:113], v[204:205], v[204:205]
    v_pk_fma_f32 v[112:113], v[112:113], v[46:47], v[44:45]
    v_pk_mul_f32 v[112:113], v[112:113], v[204:205]
    v_pk_mul_f32 v[114:115], v[206:207], v[206:207]
    v_pk_fma_f32 v[114:115], v[114:115], v[46:47], v[44:45]
    v_pk_mul_f32 v[114:115], v[114:115], v[206:207]
    v_exp_f32 v108, v108
    v_exp_f32 v109, v109
    v_exp_f32 v110, v110
    v_exp_f32 v111, v111
    v_exp_f32 v112, v112
    v_exp_f32 v113, v113
    v_exp_f32 v114, v114
    v_exp_f32 v115, v115
    v_pk_add_f32 v[108:109], v[108:109], v[48:49]
    v_pk_add_f32 v[110:111], v[110:111], v[48:49]
    v_pk_add_f32 v[112:113], v[112:113], v[48:49]
    v_pk_add_f32 v[114:115], v[114:115], v[48:49]
    v_rcp_f32 v108, v108
    v_rcp_f32 v109, v109
    v_rcp_f32 v110, v110
    v_rcp_f32 v111, v111
    v_rcp_f32 v112, v112
    v_rcp_f32 v113, v113
    v_rcp_f32 v114, v114
    v_rcp_f32 v115, v115
    v_pk_mul_f32 v[108:109], v[108:109], v[188:189]
    v_pk_mul_f32 v[110:111], v[110:111], v[190:191]
    v_pk_mul_f32 v[112:113], v[112:113], v[204:205]
    v_pk_mul_f32 v[114:115], v[114:115], v[206:207]
    v_cvt_pk_bf16_f32 v116, v108, v109
    v_cvt_pk_bf16_f32 v117, v110, v111
    v_cvt_pk_bf16_f32 v118, v112, v113
    v_cvt_pk_bf16_f32 v119, v114, v115
    s_add_u32 s37, s36, 10240
    buffer_store_dwordx4 v[116:119], v1, s[40:43], s37 offen sc0 sc1
    v_pk_mul_f32 v[120:121], v[192:193], v[192:193]
    v_pk_fma_f32 v[120:121], v[120:121], v[46:47], v[44:45]
    v_pk_mul_f32 v[120:121], v[120:121], v[192:193]
    v_pk_mul_f32 v[122:123], v[194:195], v[194:195]
    v_pk_fma_f32 v[122:123], v[122:123], v[46:47], v[44:45]
    v_pk_mul_f32 v[122:123], v[122:123], v[194:195]
    v_pk_mul_f32 v[124:125], v[208:209], v[208:209]
    v_pk_fma_f32 v[124:125], v[124:125], v[46:47], v[44:45]
    v_pk_mul_f32 v[124:125], v[124:125], v[208:209]
    v_pk_mul_f32 v[126:127], v[210:211], v[210:211]
    v_pk_fma_f32 v[126:127], v[126:127], v[46:47], v[44:45]
    v_pk_mul_f32 v[126:127], v[126:127], v[210:211]
    v_exp_f32 v120, v120
    v_exp_f32 v121, v121
    v_exp_f32 v122, v122
    v_exp_f32 v123, v123
    v_exp_f32 v124, v124
    v_exp_f32 v125, v125
    v_exp_f32 v126, v126
    v_exp_f32 v127, v127
    v_pk_add_f32 v[120:121], v[120:121], v[48:49]
    v_pk_add_f32 v[122:123], v[122:123], v[48:49]
    v_pk_add_f32 v[124:125], v[124:125], v[48:49]
    v_pk_add_f32 v[126:127], v[126:127], v[48:49]
    v_rcp_f32 v120, v120
    v_rcp_f32 v121, v121
    v_rcp_f32 v122, v122
    v_rcp_f32 v123, v123
    v_rcp_f32 v124, v124
    v_rcp_f32 v125, v125
    v_rcp_f32 v126, v126
    v_rcp_f32 v127, v127
    v_pk_mul_f32 v[120:121], v[120:121], v[192:193]
    v_pk_mul_f32 v[122:123], v[122:123], v[194:195]
    v_pk_mul_f32 v[124:125], v[124:125], v[208:209]
    v_pk_mul_f32 v[126:127], v[126:127], v[210:211]
    v_cvt_pk_bf16_f32 v128, v120, v121
    v_cvt_pk_bf16_f32 v129, v122, v123
    v_cvt_pk_bf16_f32 v130, v124, v125
    v_cvt_pk_bf16_f32 v131, v126, v127
    s_add_u32 s37, s36, 11264
    buffer_store_dwordx4 v[128:131], v1, s[40:43], s37 offen sc0 sc1
    s_mov_b32 s86, 1
    s_branch L_c_p3
L_c_idle:
    s_mov_b32 s86, 0
    s_waitcnt vmcnt(0)
    s_barrier
    s_cmp_lg_u32 s3, 0
    s_cbranch_scc1 L_cpo2
    v_mov_b32 v1, 1
    s_mov_b64 exec, 0xff
    buffer_store_dword v1, v241, s[40:43], 0 offen sc0 sc1
    s_mov_b64 exec, -1
L_cpo2:
    s_barrier
    s_barrier
    v_add_u32 v76, s38, v225
    ds_read_b64_tr_b16 v[12:13], v76 offset:0
    ds_read_b64_tr_b16 v[14:15], v76 offset:4096
    v_add_u32 v77, s38, v226
    ds_read_b64_tr_b16 v[16:17], v77 offset:0
    ds_read_b64_tr_b16 v[18:19], v77 offset:4096
    v_add_u32 v78, s38, v227
    ds_read_b64_tr_b16 v[20:21], v78 offset:0
    ds_read_b64_tr_b16 v[22:23], v78 offset:4096
    v_add_u32 v79, s38, v228
    ds_read_b64_tr_b16 v[24:25], v79 offset:0
    ds_read_b64_tr_b16 v[26:27], v79 offset:4096
    v_add_u32 v80, s38, v229
    ds_read_b128 v[28:31], v80 offset:0
    ds_read_b128 v[32:35], v80 offset:1024
    ds_read_b128 v[36:39], v80 offset:2048
    ds_read_b128 v[40:43], v80 offset:3072
L_c_p3:
    s_waitcnt lgkmcnt(0)
    v_mfma_f32_16x16x32_bf16 v[84:87], v[12:15], v[28:31], 0
    ds_read_b64_tr_b16 v[44:45], v76 offset:8192
    v_mfma_f32_16x16x32_bf16 v[88:91], v[12:15], v[32:35], 0
    ds_read_b64_tr_b16 v[46:47], v76 offset:12288
    v_mfma_f32_16x16x32_bf16 v[92:95], v[12:15], v[36:39], 0
    ds_read_b64_tr_b16 v[48:49], v77 offset:8192
    v_mfma_f32_16x16x32_bf16 v[96:99], v[12:15], v[40:43], 0
    ds_read_b64_tr_b16 v[50:51], v77 offset:12288
    v_mfma_f32_16x16x32_bf16 v[100:103], v[16:19], v[28:31], 0
    ds_read_b64_tr_b16 v[52:53], v78 offset:8192
    v_mfma_f32_16x16x32_bf16 v[104:107], v[16:19], v[32:35], 0
    ds_read_b64_tr_b16 v[54:55], v78 offset:12288
    v_mfma_f32_16x16x32_bf16 v[108:111], v[16:19], v[36:39], 0
    ds_read_b64_tr_b16 v[56:57], v79 offset:8192
    v_mfma_f32_16x16x32_bf16 v[112:115], v[16:19], v[40:43], 0
    ds_read_b64_tr_b16 v[58:59], v79 offset:12288
    v_mfma_f32_16x16x32_bf16 v[116:119], v[20:23], v[28:31], 0
    ds_read_b128 v[60:63], v80 offset:8192
    v_mfma_f32_16x16x32_bf16 v[120:123], v[20:23], v[32:35], 0
    ds_read_b128 v[64:67], v80 offset:9216
    v_mfma_f32_16x16x32_bf16 v[124:127], v[20:23], v[36:39], 0
    ds_read_b128 v[68:71], v80 offset:10240
    v_mfma_f32_16x16x32_bf16 v[128:131], v[20:23], v[40:43], 0
    ds_read_b128 v[72:75], v80 offset:11264
    v_mfma_f32_16x16x32_bf16 v[132:135], v[24:27], v[28:31], 0
    s_add_u32 s38, s38, 32768
    v_mfma_f32_16x16x32_bf16 v[136:139], v[24:27], v[32:35], 0
    s_cmp_eq_u32 s38, 163840
    v_mfma_f32_16x16x32_bf16 v[140:143], v[24:27], v[36:39], 0
    s_cselect_b32 s38, 0, s38
    v_mfma_f32_16x16x32_bf16 v[144:147], v[24:27], v[40:43], 0
    s_waitcnt lgkmcnt(0)
    s_barrier
    v_mfma_f32_16x16x32_bf16 v[84:87], v[44:47], v[60:63], v[84:87]
    v_add_u32 v76, s38, v225
    ds_read_b64_tr_b16 v[12:13], v76 offset:0
    v_mfma_f32_16x16x32_bf16 v[88:91], v[44:47], v[64:67], v[88:91]
    ds_read_b64_tr_b16 v[14:15], v76 offset:4096
    v_mfma_f32_16x16x32_bf16 v[92:95], v[44:47], v[68:71], v[92:95]
    v_add_u32 v77, s38, v226
    v_mfma_f32_16x16x32_bf16 v[96:99], v[44:47], v[72:75], v[96:99]
    ds_read_b64_tr_b16 v[16:17], v77 offset:0
    v_mfma_f32_16x16x32_bf16 v[100:103], v[48:51], v[60:63], v[100:103]
    ds_read_b64_tr_b16 v[18:19], v77 offset:4096
    v_mfma_f32_16x16x32_bf16 v[104:107], v[48:51], v[64:67], v[104:107]
    v_add_u32 v78, s38, v227
    v_mfma_f32_16x16x32_bf16 v[108:111], v[48:51], v[68:71], v[108:111]
    ds_read_b64_tr_b16 v[20:21], v78 offset:0
    v_mfma_f32_16x16x32_bf16 v[112:115], v[48:51], v[72:75], v[112:115]
    ds_read_b64_tr_b16 v[22:23], v78 offset:4096
    v_mfma_f32_16x16x32_bf16 v[116:119], v[52:55], v[60:63], v[116:119]
    v_add_u32 v79, s38, v228
    v_mfma_f32_16x16x32_bf16 v[120:123], v[52:55], v[64:67], v[120:123]
    ds_read_b64_tr_b16 v[24:25], v79 offset:0
    v_mfma_f32_16x16x32_bf16 v[124:127], v[52:55], v[68:71], v[124:127]
    ds_read_b64_tr_b16 v[26:27], v79 offset:4096
    v_mfma_f32_16x16x32_bf16 v[128:131], v[52:55], v[72:75], v[128:131]
    v_add_u32 v80, s38, v229
    v_mfma_f32_16x16x32_bf16 v[132:135], v[56:59], v[60:63], v[132:135]
    ds_read_b128 v[28:31], v80 offset:0
    v_mfma_f32_16x16x32_bf16 v[136:139], v[56:59], v[64:67], v[136:139]
    ds_read_b128 v[32:35], v80 offset:1024
    v_mfma_f32_16x16x32_bf16 v[140:143], v[56:59], v[68:71], v[140:143]
    ds_read_b128 v[36:39], v80 offset:2048
    v_mfma_f32_16x16x32_bf16 v[144:147], v[56:59], v[72:75], v[144:147]
    ds_read_b128 v[40:43], v80 offset:3072
    s_waitcnt vmcnt(0)
    s_mov_b32 s39, 0
    s_mov_b32 s33, 1
.p2align 6
L_c3aloop:
    s_waitcnt lgkmcnt(0)
    v_mfma_f32_16x16x32_bf16 v[84:87], v[12:15], v[28:31], v[84:87]
    ds_read_b64_tr_b16 v[44:45], v76 offset:8192
    v_mfma_f32_16x16x32_bf16 v[88:91], v[12:15], v[32:35], v[88:91]
    ds_read_b64_tr_b16 v[46:47], v76 offset:12288
    v_mfma_f32_16x16x32_bf16 v[92:95], v[12:15], v[36:39], v[92:95]
    ds_read_b64_tr_b16 v[48:49], v77 offset:8192
    v_mfma_f32_16x16x32_bf16 v[96:99], v[12:15], v[40:43], v[96:99]
    ds_read_b64_tr_b16 v[50:51], v77 offset:12288
    v_mfma_f32_16x16x32_bf16 v[100:103], v[16:19], v[28:31], v[100:103]
    ds_read_b64_tr_b16 v[52:53], v78 offset:8192
    v_mfma_f32_16x16x32_bf16 v[104:107], v[16:19], v[32:35], v[104:107]
    ds_read_b64_tr_b16 v[54:55], v78 offset:12288
    v_mfma_f32_16x16x32_bf16 v[108:111], v[16:19], v[36:39], v[108:111]
    ds_read_b64_tr_b16 v[56:57], v79 offset:8192
    v_mfma_f32_16x16x32_bf16 v[112:115], v[16:19], v[40:43], v[112:115]
    ds_read_b64_tr_b16 v[58:59], v79 offset:12288
    v_mfma_f32_16x16x32_bf16 v[116:119], v[20:23], v[28:31], v[116:119]
    ds_read_b128 v[60:63], v80 offset:8192
    v_mfma_f32_16x16x32_bf16 v[120:123], v[20:23], v[32:35], v[120:123]
    ds_read_b128 v[64:67], v80 offset:9216
    v_mfma_f32_16x16x32_bf16 v[124:127], v[20:23], v[36:39], v[124:127]
    ds_read_b128 v[68:71], v80 offset:10240
    v_mfma_f32_16x16x32_bf16 v[128:131], v[20:23], v[40:43], v[128:131]
    ds_read_b128 v[72:75], v80 offset:11264
    v_mfma_f32_16x16x32_bf16 v[132:135], v[24:27], v[28:31], v[132:135]
    s_add_u32 s38, s38, 32768
    v_mfma_f32_16x16x32_bf16 v[136:139], v[24:27], v[32:35], v[136:139]
    s_cmp_eq_u32 s38, 163840
    v_mfma_f32_16x16x32_bf16 v[140:143], v[24:27], v[36:39], v[140:143]
    s_cselect_b32 s38, 0, s38
    v_mfma_f32_16x16x32_bf16 v[144:147], v[24:27], v[40:43], v[144:147]
    s_waitcnt lgkmcnt(0)
    s_barrier
    v_mfma_f32_16x16x32_bf16 v[84:87], v[44:47], v[60:63], v[84:87]
    v_add_u32 v76, s38, v225
    ds_read_b64_tr_b16 v[12:13], v76 offset:0
    v_mfma_f32_16x16x32_bf16 v[88:91], v[44:47], v[64:67], v[88:91]
    ds_read_b64_tr_b16 v[14:15], v76 offset:4096
    v_add_u32 v77, s38, v226
    v_mfma_f32_16x16x32_bf16 v[92:95], v[44:47], v[68:71], v[92:95]
    ds_read_b64_tr_b16 v[16:17], v77 offset:0
    v_mfma_f32_16x16x32_bf16 v[96:99], v[44:47], v[72:75], v[96:99]
    ds_read_b64_tr_b16 v[18:19], v77 offset:4096
    v_mfma_f32_16x16x32_bf16 v[100:103], v[48:51], v[60:63], v[100:103]
    v_add_u32 v78, s38, v227
    v_mfma_f32_16x16x32_bf16 v[104:107], v[48:51], v[64:67], v[104:107]
    ds_read_b64_tr_b16 v[20:21], v78 offset:0
    v_mfma_f32_16x16x32_bf16 v[108:111], v[48:51], v[68:71], v[108:111]
    ds_read_b64_tr_b16 v[22:23], v78 offset:4096
    v_mfma_f32_16x16x32_bf16 v[112:115], v[48:51], v[72:75], v[112:115]
    v_add_u32 v79, s38, v228
    v_mfma_f32_16x16x32_bf16 v[116:119], v[52:55], v[60:63], v[116:119]
    ds_read_b64_tr_b16 v[24:25], v79 offset:0
    v_mfma_f32_16x16x32_bf16 v[120:123], v[52:55], v[64:67], v[120:123]
    ds_read_b64_tr_b16 v[26:27], v79 offset:4096
    v_mfma_f32_16x16x32_bf16 v[124:127], v[52:55], v[68:71], v[124:127]
    v_add_u32 v80, s38, v229
    v_mfma_f32_16x16x32_bf16 v[128:131], v[52:55], v[72:75], v[128:131]
    ds_read_b128 v[28:31], v80 offset:0
    v_mfma_f32_16x16x32_bf16 v[132:135], v[56:59], v[60:63], v[132:135]
    ds_read_b128 v[32:35], v80 offset:1024
    v_mfma_f32_16x16x32_bf16 v[136:139], v[56:59], v[64:67], v[136:139]
    ds_read_b128 v[36:39], v80 offset:2048
    v_mfma_f32_16x16x32_bf16 v[140:143], v[56:59], v[68:71], v[140:143]
    ds_read_b128 v[40:43], v80 offset:3072
    v_mfma_f32_16x16x32_bf16 v[144:147], v[56:59], v[72:75], v[144:147]
    s_add_u32 s39, s39, 1
    s_cmp_lt_u32 s39, s33
    s_cbranch_scc1 L_c3aloop
    s_cmp_lg_u32 s39, 1
    s_cbranch_scc1 L_c3aloop_e0
    s_cmp_eq_u32 s86, 0
    s_cbranch_scc1 L_cpu
    s_cmp_lg_u32 s3, 0
    s_cbranch_scc1 L_cpu
    v_mov_b32 v1, 1
    s_mov_b64 exec, 0xffff
    buffer_store_dword v1, v242, s[40:43], 0 offen sc0 sc1
    s_mov_b64 exec, -1
L_cpu:
    s_mov_b32 s33, 6
    s_branch L_c3aloop
L_c3aloop_e0:
    s_waitcnt lgkmcnt(0)
    v_mfma_f32_16x16x32_bf16 v[84:87], v[12:15], v[28:31], v[84:87]
    ds_read_b64_tr_b16 v[44:45], v76 offset:8192
    v_mfma_f32_16x16x32_bf16 v[88:91], v[12:15], v[32:35], v[88:91]
    ds_read_b64_tr_b16 v[46:47], v76 offset:12288
    v_mfma_f32_16x16x32_bf16 v[92:95], v[12:15], v[36:39], v[92:95]
    ds_read_b64_tr_b16 v[48:49], v77 offset:8192
    v_mfma_f32_16x16x32_bf16 v[96:99], v[12:15], v[40:43], v[96:99]
    ds_read_b64_tr_b16 v[50:51], v77 offset:12288
    v_mfma_f32_16x16x32_bf16 v[100:103], v[16:19], v[28:31], v[100:103]
    ds_read_b64_tr_b16 v[52:53], v78 offset:8192
    v_mfma_f32_16x16x32_bf16 v[104:107], v[16:19], v[32:35], v[104:107]
    ds_read_b64_tr_b16 v[54:55], v78 offset:12288
    v_mfma_f32_16x16x32_bf16 v[108:111], v[16:19], v[36:39], v[108:111]
    ds_read_b64_tr_b16 v[56:57], v79 offset:8192
    v_mfma_f32_16x16x32_bf16 v[112:115], v[16:19], v[40:43], v[112:115]
    ds_read_b64_tr_b16 v[58:59], v79 offset:12288
    v_mfma_f32_16x16x32_bf16 v[116:119], v[20:23], v[28:31], v[116:119]
    ds_read_b128 v[60:63], v80 offset:8192
    v_mfma_f32_16x16x32_bf16 v[120:123], v[20:23], v[32:35], v[120:123]
    ds_read_b128 v[64:67], v80 offset:9216
    v_mfma_f32_16x16x32_bf16 v[124:127], v[20:23], v[36:39], v[124:127]
    ds_read_b128 v[68:71], v80 offset:10240
    v_mfma_f32_16x16x32_bf16 v[128:131], v[20:23], v[40:43], v[128:131]
    ds_read_b128 v[72:75], v80 offset:11264
    v_mfma_f32_16x16x32_bf16 v[132:135], v[24:27], v[28:31], v[132:135]
    v_mfma_f32_16x16x32_bf16 v[136:139], v[24:27], v[32:35], v[136:139]
    v_mfma_f32_16x16x32_bf16 v[140:143], v[24:27], v[36:39], v[140:143]
    v_mfma_f32_16x16x32_bf16 v[144:147], v[24:27], v[40:43], v[144:147]
    s_waitcnt lgkmcnt(0)
    v_mfma_f32_16x16x32_bf16 v[84:87], v[44:47], v[60:63], v[84:87]
    v_mfma_f32_16x16x32_bf16 v[88:91], v[44:47], v[64:67], v[88:91]
    v_mfma_f32_16x16x32_bf16 v[92:95], v[44:47], v[68:71], v[92:95]
    v_mfma_f32_16x16x32_bf16 v[96:99], v[44:47], v[72:75], v[96:99]
    v_mfma_f32_16x16x32_bf16 v[100:103], v[48:51], v[60:63], v[100:103]
    v_mfma_f32_16x16x32_bf16 v[104:107], v[48:51], v[64:67], v[104:107]
    v_mfma_f32_16x16x32_bf16 v[108:111], v[48:51], v[68:71], v[108:111]
    v_mfma_f32_16x16x32_bf16 v[112:115], v[48:51], v[72:75], v[112:115]
    v_mfma_f32_16x16x32_bf16 v[116:119], v[52:55], v[60:63], v[116:119]
    v_mfma_f32_16x16x32_bf16 v[120:123], v[52:55], v[64:67], v[120:123]
    v_mfma_f32_16x16x32_bf16 v[124:127], v[52:55], v[68:71], v[124:127]
    v_mfma_f32_16x16x32_bf16 v[128:131], v[52:55], v[72:75], v[128:131]
    v_mfma_f32_16x16x32_bf16 v[132:135], v[56:59], v[60:63], v[132:135]
    v_mfma_f32_16x16x32_bf16 v[136:139], v[56:59], v[64:67], v[136:139]
    v_mfma_f32_16x16x32_bf16 v[140:143], v[56:59], v[68:71], v[140:143]
    v_mfma_f32_16x16x32_bf16 v[144:147], v[56:59], v[72:75], v[144:147]
    s_add_u32 s38, s38, 32768
    s_cmp_eq_u32 s38, 163840
    s_cselect_b32 s38, 0, s38
    v_lshlrev_b32 v252, 16, v252
    v_sub_f32 v213, 1.0, v212
    v_mul_f32 v252, v252, v213
    v_lshlrev_b32 v253, 16, v253
    v_sub_f32 v215, 1.0, v214
    v_mul_f32 v253, v253, v215
    v_lshlrev_b32 v254, 16, v254
    v_sub_f32 v217, 1.0, v216
    v_mul_f32 v254, v254, v217
    v_lshlrev_b32 v255, 16, v255
    v_sub_f32 v219, 1.0, v218
    v_mul_f32 v255, v255, v219
    s_cmp_eq_u32 s34, s8
    s_cbranch_scc1 L_fk
    v_mov_b32 v252, 0
    v_mov_b32 v253, 0
    v_mov_b32 v254, 0
    v_mov_b32 v255, 0
L_fk:
    v_pk_fma_f32 v[84:85], v[84:85], v[212:213], v[252:253] op_sel:[0,0,0] op_sel_hi:[1,0,0]
    v_pk_fma_f32 v[86:87], v[86:87], v[212:213], v[252:253] op_sel:[0,0,0] op_sel_hi:[1,0,0]
    v_pk_fma_f32 v[100:101], v[100:101], v[212:213], v[252:253] op_sel:[0,0,0] op_sel_hi:[1,0,0]
    v_pk_fma_f32 v[102:103], v[102:103], v[212:213], v[252:253] op_sel:[0,0,0] op_sel_hi:[1,0,0]
    v_pk_fma_f32 v[116:117], v[116:117], v[212:213], v[252:253] op_sel:[0,0,0] op_sel_hi:[1,0,0]
    v_pk_fma_f32 v[118:119], v[118:119], v[212:213], v[252:253] op_sel:[0,0,0] op_sel_hi:[1,0,0]
    v_pk_fma_f32 v[132:133], v[132:133], v[212:213], v[252:253] op_sel:[0,0,0] op_sel_hi:[1,0,0]
    v_pk_fma_f32 v[134:135], v[134:135], v[212:213], v[252:253] op_sel:[0,0,0] op_sel_hi:[1,0,0]
    v_pk_fma_f32 v[88:89], v[88:89], v[214:215], v[252:253] op_sel:[0,0,1] op_sel_hi:[1,0,1]
    v_pk_fma_f32 v[90:91], v[90:91], v[214:215], v[252:253] op_sel:[0,0,1] op_sel_hi:[1,0,1]
    v_pk_fma_f32 v[104:105], v[104:105], v[214:215], v[252:253] op_sel:[0,0,1] op_sel_hi:[1,0,1]
    v_pk_fma_f32 v[106:107], v[106:107], v[214:215], v[252:253] op_sel:[0,0,1] op_sel_hi:[1,0,1]
    v_pk_fma_f32 v[120:121], v[120:121], v[214:215], v[252:253] op_sel:[0,0,1] op_sel_hi:[1,0,1]
    v_pk_fma_f32 v[122:123], v[122:123], v[214:215], v[252:253] op_sel:[0,0,1] op_sel_hi:[1,0,1]
    v_pk_fma_f32 v[136:137], v[136:137], v[214:215], v[252:253] op_sel:[0,0,1] op_sel_hi:[1,0,1]
    v_pk_fma_f32 v[138:139], v[138:139], v[214:215], v[252:253] op_sel:[0,0,1] op_sel_hi:[1,0,1]
    v_pk_fma_f32 v[92:93], v[92:93], v[216:217], v[254:255] op_sel:[0,0,0] op_sel_hi:[1,0,0]
    v_pk_fma_f32 v[94:95], v[94:95], v[216:217], v[254:255] op_sel:[0,0,0] op_sel_hi:[1,0,0]
    v_pk_fma_f32 v[108:109], v[108:109], v[216:217], v[254:255] op_sel:[0,0,0] op_sel_hi:[1,0,0]
    v_pk_fma_f32 v[110:111], v[110:111], v[216:217], v[254:255] op_sel:[0,0,0] op_sel_hi:[1,0,0]
    v_pk_fma_f32 v[124:125], v[124:125], v[216:217], v[254:255] op_sel:[0,0,0] op_sel_hi:[1,0,0]
    v_pk_fma_f32 v[126:127], v[126:127], v[216:217], v[254:255] op_sel:[0,0,0] op_sel_hi:[1,0,0]
    v_pk_fma_f32 v[140:141], v[140:141], v[216:217], v[254:255] op_sel:[0,0,0] op_sel_hi:[1,0,0]
    v_pk_fma_f32 v[142:143], v[142:143], v[216:217], v[254:255] op_sel:[0,0,0] op_sel_hi:[1,0,0]
    v_pk_fma_f32 v[96:97], v[96:97], v[218:219], v[254:255] op_sel:[0,0,1] op_sel_hi:[1,0,1]
    v_pk_fma_f32 v[98:99], v[98:99], v[218:219], v[254:255] op_sel:[0,0,1] op_sel_hi:[1,0,1]
    v_pk_fma_f32 v[112:113], v[112:113], v[218:219], v[254:255] op_sel:[0,0,1] op_sel_hi:[1,0,1]
    v_pk_fma_f32 v[114:115], v[114:115], v[218:219], v[254:255] op_sel:[0,0,1] op_sel_hi:[1,0,1]
    v_pk_fma_f32 v[128:129], v[128:129], v[218:219], v[254:255] op_sel:[0,0,1] op_sel_hi:[1,0,1]
    v_pk_fma_f32 v[130:131], v[130:131], v[218:219], v[254:255] op_sel:[0,0,1] op_sel_hi:[1,0,1]
    v_pk_fma_f32 v[144:145], v[144:145], v[218:219], v[254:255] op_sel:[0,0,1] op_sel_hi:[1,0,1]
    v_pk_fma_f32 v[146:147], v[146:147], v[218:219], v[254:255] op_sel:[0,0,1] op_sel_hi:[1,0,1]
    s_barrier
    v_add_u32 v76, s38, v230
    ds_read_b64_tr_b16 v[28:29], v76 offset:0
    ds_read_b64_tr_b16 v[30:31], v76 offset:4096
    v_add_u32 v77, s38, v231
    ds_read_b64_tr_b16 v[32:33], v77 offset:0
    ds_read_b64_tr_b16 v[34:35], v77 offset:4096
    v_add_u32 v78, s38, v232
    ds_read_b64_tr_b16 v[36:37], v78 offset:0
    ds_read_b64_tr_b16 v[38:39], v78 offset:4096
    v_add_u32 v79, s38, v233
    ds_read_b64_tr_b16 v[40:41], v79 offset:0
    ds_read_b64_tr_b16 v[42:43], v79 offset:4096
    v_add_u32 v80, s38, v234
    ds_read_b128 v[12:15], v80 offset:0
    ds_read_b128 v[16:19], v80 offset:1024
    ds_read_b128 v[20:23], v80 offset:2048
    ds_read_b128 v[24:27], v80 offset:3072
    s_waitcnt lgkmcnt(0)
    v_mfma_f32_16x16x32_bf16 v[148:151], v[12:15], v[28:31], 0
    ds_read_b64_tr_b16 v[60:61], v76 offset:8192
    v_mfma_f32_16x16x32_bf16 v[152:155], v[12:15], v[32:35], 0
    ds_read_b64_tr_b16 v[62:63], v76 offset:12288
    v_mfma_f32_16x16x32_bf16 v[156:159], v[12:15], v[36:39], 0
    ds_read_b64_tr_b16 v[64:65], v77 offset:8192
    v_mfma_f32_16x16x32_bf16 v[160:163], v[12:15], v[40:43], 0
    ds_read_b64_tr_b16 v[66:67], v77 offset:12288
    v_mfma_f32_16x16x32_bf16 v[164:167], v[16:19], v[28:31], 0
    ds_read_b64_tr_b16 v[68:69], v78 offset:8192
    v_mfma_f32_16x16x32_bf16 v[168:171], v[16:19], v[32:35], 0
    ds_read_b64_tr_b16 v[70:71], v78 offset:12288
    v_mfma_f32_16x16x32_bf16 v[172:175], v[16:19], v[36:39], 0
    ds_read_b64_tr_b16 v[72:73], v79 offset:8192
    v_mfma_f32_16x16x32_bf16 v[176:179], v[16:19], v[40:43], 0
    ds_read_b64_tr_b16 v[74:75], v79 offset:12288
    v_mfma_f32_16x16x32_bf16 v[180:183], v[20:23], v[28:31], 0
    ds_read_b128 v[44:47], v80 offset:8192
    v_mfma_f32_16x16x32_bf16 v[184:187], v[20:23], v[32:35], 0
    ds_read_b128 v[48:51], v80 offset:9216
    v_mfma_f32_16x16x32_bf16 v[188:191], v[20:23], v[36:39], 0
    ds_read_b128 v[52:55], v80 offset:10240
    v_mfma_f32_16x16x32_bf16 v[192:195], v[20:23], v[40:43], 0
    ds_read_b128 v[56:59], v80 offset:11264
    v_mfma_f32_16x16x32_bf16 v[196:199], v[24:27], v[28:31], 0
    s_add_u32 s38, s38, 32768
    v_mfma_f32_16x16x32_bf16 v[200:203], v[24:27], v[32:35], 0
    s_cmp_eq_u32 s38, 163840
    v_mfma_f32_16x16x32_bf16 v[204:207], v[24:27], v[36:39], 0
    s_cselect_b32 s38, 0, s38
    v_mfma_f32_16x16x32_bf16 v[208:211], v[24:27], v[40:43], 0
    s_waitcnt lgkmcnt(0)
    s_barrier
    v_mfma_f32_16x16x32_bf16 v[148:151], v[44:47], v[60:63], v[148:151]
    v_add_u32 v76, s38, v230
    ds_read_b64_tr_b16 v[28:29], v76 offset:0
    v_mfma_f32_16x16x32_bf16 v[152:155], v[44:47], v[64:67], v[152:155]
    ds_read_b64_tr_b16 v[30:31], v76 offset:4096
    v_mfma_f32_16x16x32_bf16 v[156:159], v[44:47], v[68:71], v[156:159]
    v_add_u32 v77, s38, v231
    v_mfma_f32_16x16x32_bf16 v[160:163], v[44:47], v[72:75], v[160:163]
    ds_read_b64_tr_b16 v[32:33], v77 offset:0
    v_mfma_f32_16x16x32_bf16 v[164:167], v[48:51], v[60:63], v[164:167]
    ds_read_b64_tr_b16 v[34:35], v77 offset:4096
    v_mfma_f32_16x16x32_bf16 v[168:171], v[48:51], v[64:67], v[168:171]
    v_add_u32 v78, s38, v232
    v_mfma_f32_16x16x32_bf16 v[172:175], v[48:51], v[68:71], v[172:175]
    ds_read_b64_tr_b16 v[36:37], v78 offset:0
    v_mfma_f32_16x16x32_bf16 v[176:179], v[48:51], v[72:75], v[176:179]
    ds_read_b64_tr_b16 v[38:39], v78 offset:4096
    v_mfma_f32_16x16x32_bf16 v[180:183], v[52:55], v[60:63], v[180:183]
    v_add_u32 v79, s38, v233
    v_mfma_f32_16x16x32_bf16 v[184:187], v[52:55], v[64:67], v[184:187]
    ds_read_b64_tr_b16 v[40:41], v79 offset:0
    v_mfma_f32_16x16x32_bf16 v[188:191], v[52:55], v[68:71], v[188:191]
    ds_read_b64_tr_b16 v[42:43], v79 offset:4096
    v_mfma_f32_16x16x32_bf16 v[192:195], v[52:55], v[72:75], v[192:195]
    v_add_u32 v80, s38, v234
    v_mfma_f32_16x16x32_bf16 v[196:199], v[56:59], v[60:63], v[196:199]
    ds_read_b128 v[12:15], v80 offset:0
    v_mfma_f32_16x16x32_bf16 v[200:203], v[56:59], v[64:67], v[200:203]
    ds_read_b128 v[16:19], v80 offset:1024
    v_mfma_f32_16x16x32_bf16 v[204:207], v[56:59], v[68:71], v[204:207]
    ds_read_b128 v[20:23], v80 offset:2048
    v_mfma_f32_16x16x32_bf16 v[208:211], v[56:59], v[72:75], v[208:211]
    ds_read_b128 v[24:27], v80 offset:3072
    s_mov_b32 s39, 0
    s_mov_b32 s33, 26
.p2align 6
L_c3yloop:
    s_waitcnt lgkmcnt(0)
    v_mfma_f32_16x16x32_bf16 v[148:151], v[12:15], v[28:31], v[148:151]
    ds_read_b64_tr_b16 v[60:61], v76 offset:8192
    v_mfma_f32_16x16x32_bf16 v[152:155], v[12:15], v[32:35], v[152:155]
    ds_read_b64_tr_b16 v[62:63], v76 offset:12288
    v_mfma_f32_16x16x32_bf16 v[156:159], v[12:15], v[36:39], v[156:159]
    ds_read_b64_tr_b16 v[64:65], v77 offset:8192
    v_mfma_f32_16x16x32_bf16 v[160:163], v[12:15], v[40:43], v[160:163]
    ds_read_b64_tr_b16 v[66:67], v77 offset:12288
    v_mfma_f32_16x16x32_bf16 v[164:167], v[16:19], v[28:31], v[164:167]
    ds_read_b64_tr_b16 v[68:69], v78 offset:8192
    v_mfma_f32_16x16x32_bf16 v[168:171], v[16:19], v[32:35], v[168:171]
    ds_read_b64_tr_b16 v[70:71], v78 offset:12288
    v_mfma_f32_16x16x32_bf16 v[172:175], v[16:19], v[36:39], v[172:175]
    ds_read_b64_tr_b16 v[72:73], v79 offset:8192
    v_mfma_f32_16x16x32_bf16 v[176:179], v[16:19], v[40:43], v[176:179]
    ds_read_b64_tr_b16 v[74:75], v79 offset:12288
    v_mfma_f32_16x16x32_bf16 v[180:183], v[20:23], v[28:31], v[180:183]
    ds_read_b128 v[44:47], v80 offset:8192
    v_mfma_f32_16x16x32_bf16 v[184:187], v[20:23], v[32:35], v[184:187]
    ds_read_b128 v[48:51], v80 offset:9216
    v_mfma_f32_16x16x32_bf16 v[188:191], v[20:23], v[36:39], v[188:191]
    ds_read_b128 v[52:55], v80 offset:10240
    v_mfma_f32_16x16x32_bf16 v[192:195], v[20:23], v[40:43], v[192:195]
    ds_read_b128 v[56:59], v80 offset:11264
    v_mfma_f32_16x16x32_bf16 v[196:199], v[24:27], v[28:31], v[196:199]
    s_add_u32 s38, s38, 32768
    v_mfma_f32_16x16x32_bf16 v[200:203], v[24:27], v[32:35], v[200:203]
    s_cmp_eq_u32 s38, 163840
    v_mfma_f32_16x16x32_bf16 v[204:207], v[24:27], v[36:39], v[204:207]
    s_cselect_b32 s38, 0, s38
    v_mfma_f32_16x16x32_bf16 v[208:211], v[24:27], v[40:43], v[208:211]
    s_waitcnt lgkmcnt(0)
    s_barrier
    v_mfma_f32_16x16x32_bf16 v[148:151], v[44:47], v[60:63], v[148:151]
    v_add_u32 v76, s38, v230
    ds_read_b64_tr_b16 v[28:29], v76 offset:0
    v_mfma_f32_16x16x32_bf16 v[152:155], v[44:47], v[64:67], v[152:155]
    ds_read_b64_tr_b16 v[30:31], v76 offset:4096
    v_add_u32 v77, s38, v231
    v_mfma_f32_16x16x32_bf16 v[156:159], v[44:47], v[68:71], v[156:159]
    ds_read_b64_tr_b16 v[32:33], v77 offset:0
    v_mfma_f32_16x16x32_bf16 v[160:163], v[44:47], v[72:75], v[160:163]
    ds_read_b64_tr_b16 v[34:35], v77 offset:4096
    v_mfma_f32_16x16x32_bf16 v[164:167], v[48:51], v[60:63], v[164:167]
    v_add_u32 v78, s38, v232
    v_mfma_f32_16x16x32_bf16 v[168:171], v[48:51], v[64:67], v[168:171]
    ds_read_b64_tr_b16 v[36:37], v78 offset:0
    v_mfma_f32_16x16x32_bf16 v[172:175], v[48:51], v[68:71], v[172:175]
    ds_read_b64_tr_b16 v[38:39], v78 offset:4096
    v_mfma_f32_16x16x32_bf16 v[176:179], v[48:51], v[72:75], v[176:179]
    v_add_u32 v79, s38, v233
    v_mfma_f32_16x16x32_bf16 v[180:183], v[52:55], v[60:63], v[180:183]
    ds_read_b64_tr_b16 v[40:41], v79 offset:0
    v_mfma_f32_16x16x32_bf16 v[184:187], v[52:55], v[64:67], v[184:187]
    ds_read_b64_tr_b16 v[42:43], v79 offset:4096
    v_mfma_f32_16x16x32_bf16 v[188:191], v[52:55], v[68:71], v[188:191]
    v_add_u32 v80, s38, v234
    v_mfma_f32_16x16x32_bf16 v[192:195], v[52:55], v[72:75], v[192:195]
    ds_read_b128 v[12:15], v80 offset:0
    v_mfma_f32_16x16x32_bf16 v[196:199], v[56:59], v[60:63], v[196:199]
    ds_read_b128 v[16:19], v80 offset:1024
    v_mfma_f32_16x16x32_bf16 v[200:203], v[56:59], v[64:67], v[200:203]
    ds_read_b128 v[20:23], v80 offset:2048
    v_mfma_f32_16x16x32_bf16 v[204:207], v[56:59], v[68:71], v[204:207]
    ds_read_b128 v[24:27], v80 offset:3072
    v_mfma_f32_16x16x32_bf16 v[208:211], v[56:59], v[72:75], v[208:211]
    s_add_u32 s39, s39, 1
    s_cmp_lt_u32 s39, s33
    s_cbranch_scc1 L_c3yloop
    s_waitcnt lgkmcnt(0)
    v_mfma_f32_16x16x32_bf16 v[148:151], v[12:15], v[28:31], v[148:151]
    ds_read_b64_tr_b16 v[60:61], v76 offset:8192
    v_mfma_f32_16x16x32_bf16 v[152:155], v[12:15], v[32:35], v[152:155]
    ds_read_b64_tr_b16 v[62:63], v76 offset:12288
    v_mfma_f32_16x16x32_bf16 v[156:159], v[12:15], v[36:39], v[156:159]
    ds_read_b64_tr_b16 v[64:65], v77 offset:8192
    v_mfma_f32_16x16x32_bf16 v[160:163], v[12:15], v[40:43], v[160:163]
    ds_read_b64_tr_b16 v[66:67], v77 offset:12288
    v_mfma_f32_16x16x32_bf16 v[164:167], v[16:19], v[28:31], v[164:167]
    ds_read_b64_tr_b16 v[68:69], v78 offset:8192
    v_mfma_f32_16x16x32_bf16 v[168:171], v[16:19], v[32:35], v[168:171]
    ds_read_b64_tr_b16 v[70:71], v78 offset:12288
    v_mfma_f32_16x16x32_bf16 v[172:175], v[16:19], v[36:39], v[172:175]
    ds_read_b64_tr_b16 v[72:73], v79 offset:8192
    v_mfma_f32_16x16x32_bf16 v[176:179], v[16:19], v[40:43], v[176:179]
    ds_read_b64_tr_b16 v[74:75], v79 offset:12288
    v_mfma_f32_16x16x32_bf16 v[180:183], v[20:23], v[28:31], v[180:183]
    ds_read_b128 v[44:47], v80 offset:8192
    v_mfma_f32_16x16x32_bf16 v[184:187], v[20:23], v[32:35], v[184:187]
    ds_read_b128 v[48:51], v80 offset:9216
    v_mfma_f32_16x16x32_bf16 v[188:191], v[20:23], v[36:39], v[188:191]
    ds_read_b128 v[52:55], v80 offset:10240
    v_mfma_f32_16x16x32_bf16 v[192:195], v[20:23], v[40:43], v[192:195]
    ds_read_b128 v[56:59], v80 offset:11264
    v_mfma_f32_16x16x32_bf16 v[196:199], v[24:27], v[28:31], v[196:199]
    v_mfma_f32_16x16x32_bf16 v[200:203], v[24:27], v[32:35], v[200:203]
    v_mfma_f32_16x16x32_bf16 v[204:207], v[24:27], v[36:39], v[204:207]
    v_mfma_f32_16x16x32_bf16 v[208:211], v[24:27], v[40:43], v[208:211]
    s_waitcnt lgkmcnt(0)
    v_mfma_f32_16x16x32_bf16 v[148:151], v[44:47], v[60:63], v[148:151]
    v_mfma_f32_16x16x32_bf16 v[152:155], v[44:47], v[64:67], v[152:155]
    v_mfma_f32_16x16x32_bf16 v[156:159], v[44:47], v[68:71], v[156:159]
    v_mfma_f32_16x16x32_bf16 v[160:163], v[44:47], v[72:75], v[160:163]
    v_mfma_f32_16x16x32_bf16 v[164:167], v[48:51], v[60:63], v[164:167]
    v_mfma_f32_16x16x32_bf16 v[168:171], v[48:51], v[64:67], v[168:171]
    v_mfma_f32_16x16x32_bf16 v[172:175], v[48:51], v[68:71], v[172:175]
    v_mfma_f32_16x16x32_bf16 v[176:179], v[48:51], v[72:75], v[176:179]
    v_mfma_f32_16x16x32_bf16 v[180:183], v[52:55], v[60:63], v[180:183]
    v_mfma_f32_16x16x32_bf16 v[184:187], v[52:55], v[64:67], v[184:187]
    v_mfma_f32_16x16x32_bf16 v[188:191], v[52:55], v[68:71], v[188:191]
    v_mfma_f32_16x16x32_bf16 v[192:195], v[52:55], v[72:75], v[192:195]
    v_mfma_f32_16x16x32_bf16 v[196:199], v[56:59], v[60:63], v[196:199]
    v_mfma_f32_16x16x32_bf16 v[200:203], v[56:59], v[64:67], v[200:203]
    v_mfma_f32_16x16x32_bf16 v[204:207], v[56:59], v[68:71], v[204:207]
    v_mfma_f32_16x16x32_bf16 v[208:211], v[56:59], v[72:75], v[208:211]
    s_lshl_b32 s36, s4, 3
    s_add_u32 s36, s36, s5
    s_lshl_b32 s36, s36, 1
    s_add_u32 s36, s36, s34
    s_lshl_b32 s36, s36, 1
    s_add_u32 s36, s36, s35
    s_lshl_b32 s10, s36, 14
    s_add_u32 s10, s10, 18874368
    s_lshl_b32 s11, s36, 7
    s_add_u32 s11, s11, 27262976
    v_lshlrev_b32 v4, 4, v0
    s_cmp_eq_u32 s34, s8
    s_cbranch_scc1 L_recv
    v_pk_fma_f32 v[84:85], v[148:149], v[212:213], v[84:85] op_sel:[0,1,0] op_sel_hi:[1,1,1]
    v_pk_fma_f32 v[86:87], v[150:151], v[212:213], v[86:87] op_sel:[0,1,0] op_sel_hi:[1,1,1]
    s_add_u32 s37, s10, 0
    buffer_store_dwordx4 v[84:87], v4, s[40:43], s37 offen offset:0 sc0 sc1
    v_pk_fma_f32 v[100:101], v[164:165], v[212:213], v[100:101] op_sel:[0,1,0] op_sel_hi:[1,1,1]
    v_pk_fma_f32 v[102:103], v[166:167], v[212:213], v[102:103] op_sel:[0,1,0] op_sel_hi:[1,1,1]
    s_add_u32 s37, s10, 4096
    buffer_store_dwordx4 v[100:103], v4, s[40:43], s37 offen offset:0 sc0 sc1
    v_pk_fma_f32 v[116:117], v[180:181], v[212:213], v[116:117] op_sel:[0,1,0] op_sel_hi:[1,1,1]
    v_pk_fma_f32 v[118:119], v[182:183], v[212:213], v[118:119] op_sel:[0,1,0] op_sel_hi:[1,1,1]
    s_add_u32 s37, s10, 8192
    buffer_store_dwordx4 v[116:119], v4, s[40:43], s37 offen offset:0 sc0 sc1
    v_pk_fma_f32 v[132:133], v[196:197], v[212:213], v[132:133] op_sel:[0,1,0] op_sel_hi:[1,1,1]
    v_pk_fma_f32 v[134:135], v[198:199], v[212:213], v[134:135] op_sel:[0,1,0] op_sel_hi:[1,1,1]
    s_add_u32 s37, s10, 12288
    buffer_store_dwordx4 v[132:135], v4, s[40:43], s37 offen offset:0 sc0 sc1
    v_pk_fma_f32 v[88:89], v[152:153], v[214:215], v[88:89] op_sel:[0,1,0] op_sel_hi:[1,1,1]
    v_pk_fma_f32 v[90:91], v[154:155], v[214:215], v[90:91] op_sel:[0,1,0] op_sel_hi:[1,1,1]
    s_add_u32 s37, s10, 0
    buffer_store_dwordx4 v[88:91], v4, s[40:43], s37 offen offset:1024 sc0 sc1
    v_pk_fma_f32 v[104:105], v[168:169], v[214:215], v[104:105] op_sel:[0,1,0] op_sel_hi:[1,1,1]
    v_pk_fma_f32 v[106:107], v[170:171], v[214:215], v[106:107] op_sel:[0,1,0] op_sel_hi:[1,1,1]
    s_add_u32 s37, s10, 4096
    buffer_store_dwordx4 v[104:107], v4, s[40:43], s37 offen offset:1024 sc0 sc1
    v_pk_fma_f32 v[120:121], v[184:185], v[214:215], v[120:121] op_sel:[0,1,0] op_sel_hi:[1,1,1]
    v_pk_fma_f32 v[122:123], v[186:187], v[214:215], v[122:123] op_sel:[0,1,0] op_sel_hi:[1,1,1]
    s_add_u32 s37, s10, 8192
    buffer_store_dwordx4 v[120:123], v4, s[40:43], s37 offen offset:1024 sc0 sc1
    v_pk_fma_f32 v[136:137], v[200:201], v[214:215], v[136:137] op_sel:[0,1,0] op_sel_hi:[1,1,1]
    v_pk_fma_f32 v[138:139], v[202:203], v[214:215], v[138:139] op_sel:[0,1,0] op_sel_hi:[1,1,1]
    s_add_u32 s37, s10, 12288
    buffer_store_dwordx4 v[136:139], v4, s[40:43], s37 offen offset:1024 sc0 sc1
    v_pk_fma_f32 v[92:93], v[156:157], v[216:217], v[92:93] op_sel:[0,1,0] op_sel_hi:[1,1,1]
    v_pk_fma_f32 v[94:95], v[158:159], v[216:217], v[94:95] op_sel:[0,1,0] op_sel_hi:[1,1,1]
    s_add_u32 s37, s10, 0
    buffer_store_dwordx4 v[92:95], v4, s[40:43], s37 offen offset:2048 sc0 sc1
    v_pk_fma_f32 v[108:109], v[172:173], v[216:217], v[108:109] op_sel:[0,1,0] op_sel_hi:[1,1,1]
    v_pk_fma_f32 v[110:111], v[174:175], v[216:217], v[110:111] op_sel:[0,1,0] op_sel_hi:[1,1,1]
    s_add_u32 s37, s10, 4096
    buffer_store_dwordx4 v[108:111], v4, s[40:43], s37 offen offset:2048 sc0 sc1
    v_pk_fma_f32 v[124:125], v[188:189], v[216:217], v[124:125] op_sel:[0,1,0] op_sel_hi:[1,1,1]
    v_pk_fma_f32 v[126:127], v[190:191], v[216:217], v[126:127] op_sel:[0,1,0] op_sel_hi:[1,1,1]
    s_add_u32 s37, s10, 8192
    buffer_store_dwordx4 v[124:127], v4, s[40:43], s37 offen offset:2048 sc0 sc1
    v_pk_fma_f32 v[140:141], v[204:205], v[216:217], v[140:141] op_sel:[0,1,0] op_sel_hi:[1,1,1]
    v_pk_fma_f32 v[142:143], v[206:207], v[216:217], v[142:143] op_sel:[0,1,0] op_sel_hi:[1,1,1]
    s_add_u32 s37, s10, 12288
    buffer_store_dwordx4 v[140:143], v4, s[40:43], s37 offen offset:2048 sc0 sc1
    v_pk_fma_f32 v[96:97], v[160:161], v[218:219], v[96:97] op_sel:[0,1,0] op_sel_hi:[1,1,1]
    v_pk_fma_f32 v[98:99], v[162:163], v[218:219], v[98:99] op_sel:[0,1,0] op_sel_hi:[1,1,1]
    s_add_u32 s37, s10, 0
    buffer_store_dwordx4 v[96:99], v4, s[40:43], s37 offen offset:3072 sc0 sc1
    v_pk_fma_f32 v[112:113], v[176:177], v[218:219], v[112:113] op_sel:[0,1,0] op_sel_hi:[1,1,1]
    v_pk_fma_f32 v[114:115], v[178:179], v[218:219], v[114:115] op_sel:[0,1,0] op_sel_hi:[1,1,1]
    s_add_u32 s37, s10, 4096
    buffer_store_dwordx4 v[112:115], v4, s[40:43], s37 offen offset:3072 sc0 sc1
    v_pk_fma_f32 v[128:129], v[192:193], v[218:219], v[128:129] op_sel:[0,1,0] op_sel_hi:[1,1,1]
    v_pk_fma_f32 v[130:131], v[194:195], v[218:219], v[130:131] op_sel:[0,1,0] op_sel_hi:[1,1,1]
    s_add_u32 s37, s10, 8192
    buffer_store_dwordx4 v[128:131], v4, s[40:43], s37 offen offset:3072 sc0 sc1
    v_pk_fma_f32 v[144:145], v[208:209], v[218:219], v[144:145] op_sel:[0,1,0] op_sel_hi:[1,1,1]
    v_pk_fma_f32 v[146:147], v[210:211], v[218:219], v[146:147] op_sel:[0,1,0] op_sel_hi:[1,1,1]
    s_add_u32 s37, s10, 12288
    buffer_store_dwordx4 v[144:147], v4, s[40:43], s37 offen offset:3072 sc0 sc1
    v_mov_b32 v5, 1
    v_mov_b32 v6, 0
    s_waitcnt vmcnt(0)
    s_mov_b64 exec, 1
    buffer_store_dword v5, v6, s[40:43], s11 offen sc0 sc1
    s_mov_b64 exec, -1
    s_endpgm
L_recv:
    v_pk_fma_f32 v[84:85], v[148:149], v[212:213], v[84:85] op_sel:[0,1,0] op_sel_hi:[1,1,1]
    v_pk_fma_f32 v[86:87], v[150:151], v[212:213], v[86:87] op_sel:[0,1,0] op_sel_hi:[1,1,1]
    v_pk_fma_f32 v[100:101], v[164:165], v[212:213], v[100:101] op_sel:[0,1,0] op_sel_hi:[1,1,1]
    v_pk_fma_f32 v[102:103], v[166:167], v[212:213], v[102:103] op_sel:[0,1,0] op_sel_hi:[1,1,1]
    v_pk_fma_f32 v[116:117], v[180:181], v[212:213], v[116:117] op_sel:[0,1,0] op_sel_hi:[1,1,1]
    v_pk_fma_f32 v[118:119], v[182:183], v[212:213], v[118:119] op_sel:[0,1,0] op_sel_hi:[1,1,1]
    v_pk_fma_f32 v[132:133], v[196:197], v[212:213], v[132:133] op_sel:[0,1,0] op_sel_hi:[1,1,1]
    v_pk_fma_f32 v[134:135], v[198:199], v[212:213], v[134:135] op_sel:[0,1,0] op_sel_hi:[1,1,1]
    v_pk_fma_f32 v[88:89], v[152:153], v[214:215], v[88:89] op_sel:[0,1,0] op_sel_hi:[1,1,1]
    v_pk_fma_f32 v[90:91], v[154:155], v[214:215], v[90:91] op_sel:[0,1,0] op_sel_hi:[1,1,1]
    v_pk_fma_f32 v[104:105], v[168:169], v[214:215], v[104:105] op_sel:[0,1,0] op_sel_hi:[1,1,1]
    v_pk_fma_f32 v[106:107], v[170:171], v[214:215], v[106:107] op_sel:[0,1,0] op_sel_hi:[1,1,1]
    v_pk_fma_f32 v[120:121], v[184:185], v[214:215], v[120:121] op_sel:[0,1,0] op_sel_hi:[1,1,1]
    v_pk_fma_f32 v[122:123], v[186:187], v[214:215], v[122:123] op_sel:[0,1,0] op_sel_hi:[1,1,1]
    v_pk_fma_f32 v[136:137], v[200:201], v[214:215], v[136:137] op_sel:[0,1,0] op_sel_hi:[1,1,1]
    v_pk_fma_f32 v[138:139], v[202:203], v[214:215], v[138:139] op_sel:[0,1,0] op_sel_hi:[1,1,1]
    v_pk_fma_f32 v[92:93], v[156:157], v[216:217], v[92:93] op_sel:[0,1,0] op_sel_hi:[1,1,1]
    v_pk_fma_f32 v[94:95], v[158:159], v[216:217], v[94:95] op_sel:[0,1,0] op_sel_hi:[1,1,1]
    v_pk_fma_f32 v[108:109], v[172:173], v[216:217], v[108:109] op_sel:[0,1,0] op_sel_hi:[1,1,1]
    v_pk_fma_f32 v[110:111], v[174:175], v[216:217], v[110:111] op_sel:[0,1,0] op_sel_hi:[1,1,1]
    v_pk_fma_f32 v[124:125], v[188:189], v[216:217], v[124:125] op_sel:[0,1,0] op_sel_hi:[1,1,1]
    v_pk_fma_f32 v[126:127], v[190:191], v[216:217], v[126:127] op_sel:[0,1,0] op_sel_hi:[1,1,1]
    v_pk_fma_f32 v[140:141], v[204:205], v[216:217], v[140:141] op_sel:[0,1,0] op_sel_hi:[1,1,1]
    v_pk_fma_f32 v[142:143], v[206:207], v[216:217], v[142:143] op_sel:[0,1,0] op_sel_hi:[1,1,1]
    v_pk_fma_f32 v[96:97], v[160:161], v[218:219], v[96:97] op_sel:[0,1,0] op_sel_hi:[1,1,1]
    v_pk_fma_f32 v[98:99], v[162:163], v[218:219], v[98:99] op_sel:[0,1,0] op_sel_hi:[1,1,1]
    v_pk_fma_f32 v[112:113], v[176:177], v[218:219], v[112:113] op_sel:[0,1,0] op_sel_hi:[1,1,1]
    v_pk_fma_f32 v[114:115], v[178:179], v[218:219], v[114:115] op_sel:[0,1,0] op_sel_hi:[1,1,1]
    v_pk_fma_f32 v[128:129], v[192:193], v[218:219], v[128:129] op_sel:[0,1,0] op_sel_hi:[1,1,1]
    v_pk_fma_f32 v[130:131], v[194:195], v[218:219], v[130:131] op_sel:[0,1,0] op_sel_hi:[1,1,1]
    v_pk_fma_f32 v[144:145], v[208:209], v[218:219], v[144:145] op_sel:[0,1,0] op_sel_hi:[1,1,1]
    v_pk_fma_f32 v[146:147], v[210:211], v[218:219], v[146:147] op_sel:[0,1,0] op_sel_hi:[1,1,1]
    v_and_b32 v1, 15, v0
    v_add_u32 v1, s85, v1
    v_lshlrev_b32 v1, 11, v1
    v_bfe_u32 v2, v0, 4, 1
    v_lshl_add_u32 v1, v2, 5, v1
    v_lshrrev_b32 v2, 5, v0
    v_lshl_add_u32 v1, v2, 4, v1
    s_lshl_b32 s36, s5, 8
    s_lshl_b32 s37, s34, 7
    s_add_u32 s36, s36, s37
    v_mov_b32 v6, 0
    s_mov_b32 s38, 0
L_xpoll:
    buffer_load_dword v5, v6, s[40:43], s11 offen sc0 sc1
    s_add_u32 s38, s38, 1
    s_waitcnt vmcnt(0)
    v_readfirstlane_b32 s37, v5
    s_cmp_lg_u32 s37, 0
    s_cbranch_scc1 L_got
    s_cmp_lt_u32 s38, 32768
    s_cbranch_scc1 L_xpoll
L_got:
    s_add_u32 s37, s10, 0
    buffer_load_dwordx4 v[148:151], v4, s[40:43], s37 offen offset:0 sc0 sc1
    buffer_load_dwordx4 v[152:155], v4, s[40:43], s37 offen offset:1024 sc0 sc1
    buffer_load_dwordx4 v[156:159], v4, s[40:43], s37 offen offset:2048 sc0 sc1
    buffer_load_dwordx4 v[160:163], v4, s[40:43], s37 offen offset:3072 sc0 sc1
    s_add_u32 s37, s10, 4096
    buffer_load_dwordx4 v[164:167], v4, s[40:43], s37 offen offset:0 sc0 sc1
    buffer_load_dwordx4 v[168:171], v4, s[40:43], s37 offen offset:1024 sc0 sc1
    buffer_load_dwordx4 v[172:175], v4, s[40:43], s37 offen offset:2048 sc0 sc1
    buffer_load_dwordx4 v[176:179], v4, s[40:43], s37 offen offset:3072 sc0 sc1
    s_add_u32 s37, s10, 8192
    buffer_load_dwordx4 v[180:183], v4, s[40:43], s37 offen offset:0 sc0 sc1
    buffer_load_dwordx4 v[184:187], v4, s[40:43], s37 offen offset:1024 sc0 sc1
    buffer_load_dwordx4 v[188:191], v4, s[40:43], s37 offen offset:2048 sc0 sc1
    buffer_load_dwordx4 v[192:195], v4, s[40:43], s37 offen offset:3072 sc0 sc1
    s_add_u32 s37, s10, 12288
    buffer_load_dwordx4 v[196:199], v4, s[40:43], s37 offen offset:0 sc0 sc1
    buffer_load_dwordx4 v[200:203], v4, s[40:43], s37 offen offset:1024 sc0 sc1
    buffer_load_dwordx4 v[204:207], v4, s[40:43], s37 offen offset:2048 sc0 sc1
    buffer_load_dwordx4 v[208:211], v4, s[40:43], s37 offen offset:3072 sc0 sc1
    s_waitcnt vmcnt(8)
    v_pk_add_f32 v[84:85], v[84:85], v[148:149]
    v_cvt_pk_bf16_f32 v12, v84, v85
    v_pk_add_f32 v[86:87], v[86:87], v[150:151]
    v_cvt_pk_bf16_f32 v13, v86, v87
    v_pk_add_f32 v[100:101], v[100:101], v[164:165]
    v_cvt_pk_bf16_f32 v14, v100, v101
    v_pk_add_f32 v[102:103], v[102:103], v[166:167]
    v_cvt_pk_bf16_f32 v15, v102, v103
    s_nop 1
    v_permlane16_swap_b32 v12, v14
    v_permlane16_swap_b32 v13, v15
    s_add_u32 s37, s36, 0
    buffer_store_dwordx4 v[12:15], v1, s[76:79], s37 offen offset:0
    v_pk_add_f32 v[88:89], v[88:89], v[152:153]
    v_cvt_pk_bf16_f32 v16, v88, v89
    v_pk_add_f32 v[90:91], v[90:91], v[154:155]
    v_cvt_pk_bf16_f32 v17, v90, v91
    v_pk_add_f32 v[104:105], v[104:105], v[168:169]
    v_cvt_pk_bf16_f32 v18, v104, v105
    v_pk_add_f32 v[106:107], v[106:107], v[170:171]
    v_cvt_pk_bf16_f32 v19, v106, v107
    s_nop 1
    v_permlane16_swap_b32 v16, v18
    v_permlane16_swap_b32 v17, v19
    s_add_u32 s37, s36, 32768
    buffer_store_dwordx4 v[16:19], v1, s[76:79], s37 offen offset:0
    v_pk_add_f32 v[92:93], v[92:93], v[156:157]
    v_cvt_pk_bf16_f32 v20, v92, v93
    v_pk_add_f32 v[94:95], v[94:95], v[158:159]
    v_cvt_pk_bf16_f32 v21, v94, v95
    v_pk_add_f32 v[108:109], v[108:109], v[172:173]
    v_cvt_pk_bf16_f32 v22, v108, v109
    v_pk_add_f32 v[110:111], v[110:111], v[174:175]
    v_cvt_pk_bf16_f32 v23, v110, v111
    s_nop 1
    v_permlane16_swap_b32 v20, v22
    v_permlane16_swap_b32 v21, v23
    s_add_u32 s37, s36, 65536
    buffer_store_dwordx4 v[20:23], v1, s[76:79], s37 offen offset:0
    v_pk_add_f32 v[96:97], v[96:97], v[160:161]
    v_cvt_pk_bf16_f32 v24, v96, v97
    v_pk_add_f32 v[98:99], v[98:99], v[162:163]
    v_cvt_pk_bf16_f32 v25, v98, v99
    v_pk_add_f32 v[112:113], v[112:113], v[176:177]
    v_cvt_pk_bf16_f32 v26, v112, v113
    v_pk_add_f32 v[114:115], v[114:115], v[178:179]
    v_cvt_pk_bf16_f32 v27, v114, v115
    s_nop 1
    v_permlane16_swap_b32 v24, v26
    v_permlane16_swap_b32 v25, v27
    s_add_u32 s37, s36, 98304
    buffer_store_dwordx4 v[24:27], v1, s[76:79], s37 offen offset:0
    s_waitcnt vmcnt(4)
    v_pk_add_f32 v[116:117], v[116:117], v[180:181]
    v_cvt_pk_bf16_f32 v12, v116, v117
    v_pk_add_f32 v[118:119], v[118:119], v[182:183]
    v_cvt_pk_bf16_f32 v13, v118, v119
    v_pk_add_f32 v[132:133], v[132:133], v[196:197]
    v_cvt_pk_bf16_f32 v14, v132, v133
    v_pk_add_f32 v[134:135], v[134:135], v[198:199]
    v_cvt_pk_bf16_f32 v15, v134, v135
    s_nop 1
    v_permlane16_swap_b32 v12, v14
    v_permlane16_swap_b32 v13, v15
    s_add_u32 s37, s36, 0
    buffer_store_dwordx4 v[12:15], v1, s[76:79], s37 offen offset:64
    v_pk_add_f32 v[120:121], v[120:121], v[184:185]
    v_cvt_pk_bf16_f32 v16, v120, v121
    v_pk_add_f32 v[122:123], v[122:123], v[186:187]
    v_cvt_pk_bf16_f32 v17, v122, v123
    v_pk_add_f32 v[136:137], v[136:137], v[200:201]
    v_cvt_pk_bf16_f32 v18, v136, v137
    v_pk_add_f32 v[138:139], v[138:139], v[202:203]
    v_cvt_pk_bf16_f32 v19, v138, v139
    s_nop 1
    v_permlane16_swap_b32 v16, v18
    v_permlane16_swap_b32 v17, v19
    s_add_u32 s37, s36, 32768
    buffer_store_dwordx4 v[16:19], v1, s[76:79], s37 offen offset:64
    v_pk_add_f32 v[124:125], v[124:125], v[188:189]
    v_cvt_pk_bf16_f32 v20, v124, v125
    v_pk_add_f32 v[126:127], v[126:127], v[190:191]
    v_cvt_pk_bf16_f32 v21, v126, v127
    v_pk_add_f32 v[140:141], v[140:141], v[204:205]
    v_cvt_pk_bf16_f32 v22, v140, v141
    v_pk_add_f32 v[142:143], v[142:143], v[206:207]
    v_cvt_pk_bf16_f32 v23, v142, v143
    s_nop 1
    v_permlane16_swap_b32 v20, v22
    v_permlane16_swap_b32 v21, v23
    s_add_u32 s37, s36, 65536
    buffer_store_dwordx4 v[20:23], v1, s[76:79], s37 offen offset:64
    v_pk_add_f32 v[128:129], v[128:129], v[192:193]
    v_cvt_pk_bf16_f32 v24, v128, v129
    v_pk_add_f32 v[130:131], v[130:131], v[194:195]
    v_cvt_pk_bf16_f32 v25, v130, v131
    v_pk_add_f32 v[144:145], v[144:145], v[208:209]
    v_cvt_pk_bf16_f32 v26, v144, v145
    v_pk_add_f32 v[146:147], v[146:147], v[210:211]
    v_cvt_pk_bf16_f32 v27, v146, v147
    s_nop 1
    v_permlane16_swap_b32 v24, v26
    v_permlane16_swap_b32 v25, v27
    s_add_u32 s37, s36, 98304
    buffer_store_dwordx4 v[24:27], v1, s[76:79], s37 offen offset:64
    s_endpgm
L_codeend:
.section .rodata,"a"
.p2align 6
.amdhsa_kernel gated_mix__sliding_local_dilated__mixer_token_mlp__prompt_kernel
  .amdhsa_next_free_vgpr 256
  .amdhsa_next_free_sgpr 102
  .amdhsa_accum_offset 256
  .amdhsa_group_segment_fixed_size 0
  .amdhsa_kernarg_size 96
  .amdhsa_user_sgpr_count 2
  .amdhsa_user_sgpr_kernarg_segment_ptr 1
  .amdhsa_system_sgpr_workgroup_id_x 1
.end_amdhsa_kernel
```
